```python
import torch

def _softmax(x, axis=-1):
    return torch.softmax(x, dim=axis)
def _gelu(x):
    return torch.nn.functional.gelu(x, approximate="tanh")
def _silu(x):
    return torch.nn.functional.silu(x)
def _sigmoid(x):
    return torch.sigmoid(x)
def _layernorm(x, axis=-1, eps=1e-5):
    m = x.mean(dim=axis, keepdim=True)
    v = x.var(dim=axis, keepdim=True, unbiased=False)
    return (x - m) / torch.sqrt(v + eps)
def _scatter_add(tgt, idx, src, axis=0):
    return tgt.clone().index_add_(axis, idx, src)
def _segment_sum(src, seg, n):
    out = torch.zeros((n,) + src.shape[1:], dtype=src.dtype)
    return out.index_add_(0, seg, src)
def _pad(x, pw):
    flat = tuple(v for pair in reversed(pw) for v in pair)
    return torch.nn.functional.pad(x, flat)

kernel_name = 'parallel_sum__mha_block__mixer_s_mlp__prompt'

def setup_inputs():

    _w = (lambda a: (lambda t: t.to(torch.bfloat16) if t.is_floating_point() else t)(torch.as_tensor(a)))
    def _A_setup():
        B, S, D, H = 1, 2048, 448, 16
        return {
            "x": _w((lambda *s: torch.randn(*s, dtype=torch.bfloat16) * 0.05)(B, S, D)),
            "wqkv": _w((lambda *s: torch.randn(*s, dtype=torch.bfloat16) * 0.1)(D, 3 * D)),
            "wo": _w((lambda *s: torch.randn(*s, dtype=torch.bfloat16) * 0.05)(D, D)),
        }
    _A_in = _A_setup()

    def _B_setup():
        B, S, D, F = 1, 2048, 448, 1792
        return {
            "x":  _w((lambda *s: torch.randn(*s, dtype=torch.bfloat16) * 0.05)(B, S, D)),
            "w1": _w((lambda *s: torch.randn(*s, dtype=torch.bfloat16) * 1.6)(D, D) * (D ** -0.5)),
            "w2": _w((lambda *s: torch.randn(*s, dtype=torch.bfloat16) * 1.6)(D, D) * (D ** -0.5)),
            "w3": _w((lambda *s: torch.randn(*s, dtype=torch.bfloat16) * 1.6)(D, F) * (D ** -0.5)),
            "w4": _w((lambda *s: torch.randn(*s, dtype=torch.bfloat16) * 1.6)(F, D) * (F ** -0.5)),
        }
    _B_in = _B_setup()

    return {
        "A_x": _A_in["x"],
        "A_wqkv": _A_in["wqkv"],
        "A_wo": _A_in["wo"],
        "B_x": _B_in["x"],
        "B_w1": _B_in["w1"],
        "B_w2": _B_in["w2"],
        "B_w3": _B_in["w3"],
        "B_w4": _B_in["w4"],
    }

def reference(A_x, A_wqkv, A_wo, B_x, B_w1, B_w2, B_w3, B_w4):
    def _A_ref(x, wqkv, wo):
        B, S, D = x.shape
        H = 16
        Dh = D // H
        qkv = (lambda x, *d: x.permute(*d))((x @ wqkv).reshape(B, S, 3, H, Dh), 2, 0, 3, 1, 4)
        q, k, v = qkv[0], qkv[1], qkv[2]
        scores = torch.einsum("bhqd,bhkd->bhqk", q, k) * (Dh ** -0.5)
        p = _softmax(scores, axis=-1)
        o = torch.einsum("bhqk,bhkd->bhqd", p, v)
        return (lambda x, *d: x.permute(*d))(o, 0, 2, 1, 3).reshape(B, S, D) @ wo

    def _B_ref(x, w1, w2, w3, w4):
        B, S, D = x.shape
        h = _gelu(_layernorm(x, axis=-1) @ w1)
        c = D // 4
        g0 = _pad(h[:, :, 0*c:1*c], ((0, 0), (1, 0), (0, 0)))[:, :S, :]
        g1 = _pad(h[:, :, 1*c:2*c], ((0, 0), (0, 1), (0, 0)))[:, 1:, :]
        g2 = _pad(h[:, :, 2*c:3*c], ((0, 0), (2, 0), (0, 0)))[:, :S, :]
        g3 = _pad(h[:, :, 3*c:   ], ((0, 0), (0, 2), (0, 0)))[:, 2:, :]
        hs = torch.concatenate([g0, g1, g2, g3], axis=-1) @ w2
        x1 = x + hs
        h2 = _gelu(_layernorm(x1, axis=-1) @ w3) @ w4
        return x1 + h2

    x = A_x
    xn = _layernorm(x, axis=-1)
    return x + _A_ref(xn, A_wqkv, A_wo) + _B_ref(xn, B_w1, B_w2, B_w3, B_w4)
```

```asm
; @launch grid=(256,1,1) block=(512,1,1) lds=163840
.amdgcn_target "amdgcn-amd-amdhsa--gfx950"
.text
.globl parallel_sum__mha_block__mixer_s_mlp__prompt_kernel
.p2align 8
.type parallel_sum__mha_block__mixer_s_mlp__prompt_kernel,@function
parallel_sum__mha_block__mixer_s_mlp__prompt_kernel:
K_start:
    s_cmp_ge_u32 s2, 256
    s_cbranch_scc1 K_end
    s_load_dwordx16 s[4:19], s[0:1], 0
    s_load_dwordx4 s[20:23], s[0:1], 64
    s_load_dwordx2 s[24:25], s[0:1], 80
    v_and_b32 v1, 63, v0
    v_lshrrev_b32 v8, 6, v0
    s_mov_b32 s59, 0x71800000
    v_readfirstlane_b32 s60, v8
    v_lshlrev_b32 v0, 4, v1
    s_nop 0
    s_and_b32 s46, s60, 3
    s_cmp_ge_u32 s60, 4
    s_cbranch_scc0 K_rolea
    s_lshr_b32 s57, s2, 3
    s_cmp_ge_u32 s57, 5
    s_cbranch_scc1 PB_nopf
    s_cmp_lg_u32 s46, 0
    s_cbranch_scc1 PB_nopf
    s_getpc_b64 s[62:63]
PB_pc:
    s_lshl_b32 s57, s57, 13
    s_sub_u32 s62, s62, PB_pc-K_start
    s_subb_u32 s63, s63, 0
    s_add_u32 s62, s62, s57
    s_addc_u32 s63, s63, 0
    v_lshlrev_b32 v8, 7, v1
    v_add_u32 v9, s57, v8
    v_cmp_gt_u32 vcc, K_last-K_start, v9
    v_mov_b32 v11, s63
    v_add_co_u32 v10, s[98:99], s62, v8
    s_nop 1
    v_addc_co_u32 v11, s[98:99], 0, v11, s[98:99]
    s_and_saveexec_b64 s[98:99], vcc
    s_cbranch_execz PB_pfx
    global_load_dword v16, v[10:11], off
PB_pfx:
    s_mov_b64 exec, -1
PB_nopf:
    s_and_b32 s26, s2, 1
    s_lshl_b32 s26, s26, 3
    s_lshr_b32 s3, s2, 5
    s_add_u32 s26, s26, s3
    s_bfe_u32 s51, s2, 0x20003
    s_lshl_b32 s54, s51, 1
    s_add_u32 s54, s54, s3
    s_mul_i32 s3, s54, 37
    s_lshr_b32 s3, s3, 8
    s_mul_i32 s3, s3, 7
    s_sub_u32 s54, s54, s3
    s_mul_i32 s54, s54, 1
    s_bfe_u32 s3, s2, 0x20001
    s_lshl_b32 s3, s3, 2
    s_add_u32 s3, s3, s51
    s_lshl_b32 s3, s3, 2
    s_add_u32 s3, s3, s46
    s_lshl_b32 s56, s3, 5
    s_and_b32 s27, s26, 3
    s_lshr_b32 s3, s27, 1
    s_add_u32 s3, s3, 1
    s_sub_u32 s57, 0, s3
    s_bitcmp1_b32 s27, 0
    s_cselect_b32 s3, s3, s57
    s_movk_i32 s49, 2688
    s_cmp_ge_u32 s26, 12
    s_cselect_b32 s3, s3, 0
    s_cselect_b32 s49, 896, s49
    s_cselect_b32 s27, s27, s26
    s_add_u32 s56, s56, s3
    s_mul_i32 s52, s27, 224
    v_lshrrev_b32 v8, 3, v1
    v_add_u32 v8, s56, v8
    s_movk_i32 s3, 896
    v_mul_i32_i24 v8, s3, v8
    v_bfe_u32 v9, v1, 4, 2
    v_and_b32 v10, 7, v1
    v_xor_b32 v9, v9, v10
    v_lshl_add_u32 v2, v9, 4, v8
    v_xor_b32 v9, 4, v9
    v_lshl_add_u32 v3, v9, 4, v8
    v_add_u32 v3, 7168, v3
    v_add_u32 v4, 14336, v2
    v_add_u32 v5, 14336, v3
    v_lshrrev_b32 v8, 4, v1
    v_lshlrev_b32 v9, 2, v8
    v_sub_u32 v9, v1, v9
    v_and_b32 v9, 15, v9
    v_mul_u32_u24 v8, s49, v8
    v_lshl_add_u32 v7, v9, 4, v8
    v_cmp_gt_u32 s[96:97], 14, v9
    s_lshl_b32 s51, s54, 6
    s_lshl_b32 s54, s54, 7
    s_lshl_b32 s3, s46, 4
    s_mul_i32 s3, s3, s49
    s_add_u32 s52, s52, s3
    s_lshl_b32 s53, s49, 2
    s_lshl_b32 s55, s46, 12
    s_waitcnt lgkmcnt(0)
    s_mov_b32 s28, s4
    s_mov_b32 s29, s5
    s_mov_b32 s30, 1835008
    s_mov_b32 s31, 0x20000
    s_add_u32 m0, s55, 114688
    s_nop 0
    buffer_load_dwordx4 v2, s[28:31], s54 offen lds
    s_add_u32 m0, s55, 115712
    s_nop 0
    buffer_load_dwordx4 v3, s[28:31], s54 offen lds
    s_add_u32 m0, s55, 116736
    s_nop 0
    buffer_load_dwordx4 v4, s[28:31], s54 offen lds
    s_add_u32 m0, s55, 117760
    s_nop 0
    buffer_load_dwordx4 v5, s[28:31], s54 offen lds
    s_add_u32 s54, s54, 128
    s_cmp_eq_u32 s54, 896
    s_cselect_b32 s54, 0, s54
    s_cmp_ge_u32 s26, 12
    s_cselect_b32 s32, s12, s6
    s_cselect_b32 s33, s13, s7
    s_mul_i32 s34, s49, 448
    s_mov_b32 s35, 0x20000
    s_mul_i32 s50, s51, s49
    s_add_u32 s50, s50, s52
    s_add_u32 s51, s51, 64
    s_cmp_eq_u32 s51, 448
    s_cselect_b32 s51, 0, s51
    s_mov_b64 exec, s[96:97]
    s_add_u32 m0, s55, 0
    s_nop 0
    buffer_load_dwordx4 v7, s[32:35], s50 offen lds
    s_add_u32 m0, s55, 1024
    s_add_u32 s50, s50, s53
    buffer_load_dwordx4 v7, s[32:35], s50 offen lds
    s_add_u32 m0, s55, 2048
    s_add_u32 s50, s50, s53
    buffer_load_dwordx4 v7, s[32:35], s50 offen lds
    s_add_u32 m0, s55, 3072
    s_add_u32 s50, s50, s53
    buffer_load_dwordx4 v7, s[32:35], s50 offen lds
    s_mov_b64 exec, -1
    s_mov_b32 s36, s24
    s_mov_b32 s37, s25
    s_mov_b32 s38, 27262976
    s_mov_b32 s39, 0x20000
    s_lshl_b32 s61, s46, 8
    s_or_b32 s61, s61, s2
    v_mov_b32 v22, 0
    s_cmp_ge_u32 s61, 20
    s_cbranch_scc1 PB_noinit
    v_lshlrev_b32 v13, 7, v1
    s_lshl_b32 s3, s2, 13
    s_add_u32 s3, s3, 22347776
    buffer_store_dword v22, v13, s[36:39], s3 offen sc1
PB_noinit:
    v_lshrrev_b32 v8, 1, v1
    v_and_b32 v9, 15, v8
    v_lshrrev_b32 v10, 4, v8
    v_lshlrev_b32 v10, 14, v10
    v_lshl_add_u32 v10, v9, 8, v10
    v_and_b32 v9, 3, v8
    v_lshlrev_b32 v9, 2, v9
    v_and_b32 v8, 1, v1
    v_add3_u32 v9, v9, v8, 14
    v_and_b32 v9, 15, v9
    v_lshl_add_u32 v10, v9, 4, v10
    v_add_u32 v10, s55, v10
    v_add_u32 v11, 0x10000, v10
    v_mov_b32 v12, 0x3f803f80
    v_mov_b32 v13, v12
    v_mov_b32 v14, v12
    v_mov_b32 v15, v12
    ds_write_b128 v10, v[12:15]
    ds_write_b128 v10, v[12:15] offset:32768
    ds_write_b128 v11, v[12:15]
    s_mov_b64 exec, 0xffffffff
    ds_write_b128 v11, v[12:15] offset:32768
    s_mov_b64 exec, -1
    s_mov_b32 s36, s24
    s_mov_b32 s37, s25
    s_mov_b32 s38, 27262976
    s_mov_b32 s39, 0x20000
    s_mov_b32 s40, s22
    s_mov_b32 s41, s23
    s_mov_b32 s42, 256
    s_mov_b32 s43, 0x20000
    s_add_u32 m0, s55, 131072
    s_nop 0
    buffer_load_dwordx4 v2, s[28:31], s54 offen lds
    s_add_u32 m0, s55, 132096
    s_nop 0
    buffer_load_dwordx4 v3, s[28:31], s54 offen lds
    s_add_u32 m0, s55, 133120
    s_nop 0
    buffer_load_dwordx4 v4, s[28:31], s54 offen lds
    s_add_u32 m0, s55, 134144
    s_nop 0
    buffer_load_dwordx4 v5, s[28:31], s54 offen lds
    s_add_u32 s54, s54, 128
    s_cmp_eq_u32 s54, 896
    s_cselect_b32 s54, 0, s54
    s_mul_i32 s50, s51, s49
    s_add_u32 s50, s50, s52
    s_add_u32 s51, s51, 64
    s_cmp_eq_u32 s51, 448
    s_cselect_b32 s51, 0, s51
    s_mov_b64 exec, s[96:97]
    s_add_u32 m0, s55, 16384
    s_nop 0
    buffer_load_dwordx4 v7, s[32:35], s50 offen lds
    s_add_u32 m0, s55, 17408
    s_add_u32 s50, s50, s53
    buffer_load_dwordx4 v7, s[32:35], s50 offen lds
    s_add_u32 m0, s55, 18432
    s_add_u32 s50, s50, s53
    buffer_load_dwordx4 v7, s[32:35], s50 offen lds
    s_add_u32 m0, s55, 19456
    s_add_u32 s50, s50, s53
    buffer_load_dwordx4 v7, s[32:35], s50 offen lds
    s_mov_b64 exec, -1
    s_bfe_u32 s26, s2, 0x20001
    s_lshl_b32 s26, s26, 2
    s_bfe_u32 s3, s2, 0x20003
    s_add_u32 s26, s26, s3
    s_lshl_b32 s44, s26, 1
    s_and_b32 s3, s2, 1
    s_add_u32 s44, s44, s3
    s_lshr_b32 s45, s2, 5
    s_and_b32 s3, s46, 1
    s_lshl_b32 s48, s44, 1
    s_add_u32 s48, s48, s3
    s_waitcnt vmcnt(8) lgkmcnt(0)
    s_barrier
    s_add_u32 m0, s55, 147456
    s_nop 0
    buffer_load_dwordx4 v2, s[28:31], s54 offen lds
    s_add_u32 m0, s55, 148480
    s_nop 0
    buffer_load_dwordx4 v3, s[28:31], s54 offen lds
    s_add_u32 m0, s55, 149504
    s_nop 0
    buffer_load_dwordx4 v4, s[28:31], s54 offen lds
    s_add_u32 m0, s55, 150528
    s_nop 0
    buffer_load_dwordx4 v5, s[28:31], s54 offen lds
    s_add_u32 s54, s54, 128
    s_cmp_eq_u32 s54, 896
    s_cselect_b32 s54, 0, s54
    s_mul_i32 s50, s51, s49
    s_add_u32 s50, s50, s52
    s_add_u32 s51, s51, 64
    s_cmp_eq_u32 s51, 448
    s_cselect_b32 s51, 0, s51
    s_mov_b64 exec, s[96:97]
    s_add_u32 m0, s55, 32768
    s_nop 0
    buffer_load_dwordx4 v7, s[32:35], s50 offen lds
    s_add_u32 m0, s55, 33792
    s_add_u32 s50, s50, s53
    buffer_load_dwordx4 v7, s[32:35], s50 offen lds
    s_add_u32 m0, s55, 34816
    s_add_u32 s50, s50, s53
    buffer_load_dwordx4 v7, s[32:35], s50 offen lds
    s_add_u32 m0, s55, 35840
    s_add_u32 s50, s50, s53
    buffer_load_dwordx4 v7, s[32:35], s50 offen lds
    s_mov_b64 exec, -1
    s_waitcnt vmcnt(8) lgkmcnt(0)
    s_barrier
    s_cmp_ge_u32 s61, 20
    s_cbranch_scc1 PB_noset
    s_lshl_b32 s3, s2, 2
    v_mov_b32 v9, 1
    s_mov_b64 exec, 1
    buffer_store_dword v9, v22, s[40:43], s3 offen sc1
    s_mov_b64 exec, -1
PB_noset:
    s_add_u32 m0, s55, 114688
    s_nop 0
    buffer_load_dwordx4 v2, s[28:31], s54 offen lds
    s_add_u32 m0, s55, 115712
    s_nop 0
    buffer_load_dwordx4 v3, s[28:31], s54 offen lds
    s_add_u32 m0, s55, 116736
    s_nop 0
    buffer_load_dwordx4 v4, s[28:31], s54 offen lds
    s_add_u32 m0, s55, 117760
    s_nop 0
    buffer_load_dwordx4 v5, s[28:31], s54 offen lds
    s_add_u32 s54, s54, 128
    s_cmp_eq_u32 s54, 896
    s_cselect_b32 s54, 0, s54
    s_mul_i32 s50, s51, s49
    s_add_u32 s50, s50, s52
    s_add_u32 s51, s51, 64
    s_cmp_eq_u32 s51, 448
    s_cselect_b32 s51, 0, s51
    s_mov_b64 exec, s[96:97]
    s_add_u32 m0, s55, 49152
    s_nop 0
    buffer_load_dwordx4 v7, s[32:35], s50 offen lds
    s_add_u32 m0, s55, 50176
    s_add_u32 s50, s50, s53
    buffer_load_dwordx4 v7, s[32:35], s50 offen lds
    s_add_u32 m0, s55, 51200
    s_add_u32 s50, s50, s53
    buffer_load_dwordx4 v7, s[32:35], s50 offen lds
    s_add_u32 m0, s55, 52224
    s_add_u32 s50, s50, s53
    buffer_load_dwordx4 v7, s[32:35], s50 offen lds
    s_mov_b64 exec, -1
    s_waitcnt vmcnt(8) lgkmcnt(0)
    s_barrier
    s_add_u32 m0, s55, 131072
    s_nop 0
    buffer_load_dwordx4 v2, s[28:31], s54 offen lds
    s_add_u32 m0, s55, 132096
    s_nop 0
    buffer_load_dwordx4 v3, s[28:31], s54 offen lds
    s_add_u32 m0, s55, 133120
    s_nop 0
    buffer_load_dwordx4 v4, s[28:31], s54 offen lds
    s_add_u32 m0, s55, 134144
    s_nop 0
    buffer_load_dwordx4 v5, s[28:31], s54 offen lds
    s_add_u32 s54, s54, 128
    s_cmp_eq_u32 s54, 896
    s_cselect_b32 s54, 0, s54
    s_mul_i32 s50, s51, s49
    s_add_u32 s50, s50, s52
    s_add_u32 s51, s51, 64
    s_cmp_eq_u32 s51, 448
    s_cselect_b32 s51, 0, s51
    s_mov_b64 exec, s[96:97]
    s_add_u32 m0, s55, 65536
    s_nop 0
    buffer_load_dwordx4 v7, s[32:35], s50 offen lds
    s_add_u32 m0, s55, 66560
    s_add_u32 s50, s50, s53
    buffer_load_dwordx4 v7, s[32:35], s50 offen lds
    s_add_u32 m0, s55, 67584
    s_add_u32 s50, s50, s53
    buffer_load_dwordx4 v7, s[32:35], s50 offen lds
    s_add_u32 m0, s55, 68608
    s_add_u32 s50, s50, s53
    buffer_load_dwordx4 v7, s[32:35], s50 offen lds
    s_mov_b64 exec, -1
    s_mov_b32 s40, s14
    s_mov_b32 s41, s15
    s_mov_b32 s42, 401408
    s_mov_b32 s43, 0x20000
    v_lshlrev_b32 v8, 7, v1
    s_lshr_b32 s57, s2, 3
    s_lshl_b32 s57, s57, 2
    s_add_u32 s57, s57, s46
    s_mul_i32 s3, s57, 3200
    s_bfm_b64 exec, 25, 0
    buffer_load_dword v16, v8, s[40:43], s3 offen
    s_mov_b64 exec, -1
    s_waitcnt vmcnt(9) lgkmcnt(0)
    s_barrier
    s_add_u32 m0, s55, 147456
    s_nop 0
    buffer_load_dwordx4 v2, s[28:31], s54 offen lds
    s_add_u32 m0, s55, 148480
    s_nop 0
    buffer_load_dwordx4 v3, s[28:31], s54 offen lds
    s_add_u32 m0, s55, 149504
    s_nop 0
    buffer_load_dwordx4 v4, s[28:31], s54 offen lds
    s_add_u32 m0, s55, 150528
    s_nop 0
    buffer_load_dwordx4 v5, s[28:31], s54 offen lds
    s_add_u32 s54, s54, 128
    s_cmp_eq_u32 s54, 896
    s_cselect_b32 s54, 0, s54
    s_mul_i32 s50, s51, s49
    s_add_u32 s50, s50, s52
    s_add_u32 s51, s51, 64
    s_cmp_eq_u32 s51, 448
    s_cselect_b32 s51, 0, s51
    s_mov_b64 exec, s[96:97]
    s_add_u32 m0, s55, 81920
    s_nop 0
    buffer_load_dwordx4 v7, s[32:35], s50 offen lds
    s_add_u32 m0, s55, 82944
    s_add_u32 s50, s50, s53
    buffer_load_dwordx4 v7, s[32:35], s50 offen lds
    s_add_u32 m0, s55, 83968
    s_add_u32 s50, s50, s53
    buffer_load_dwordx4 v7, s[32:35], s50 offen lds
    s_add_u32 m0, s55, 84992
    s_add_u32 s50, s50, s53
    buffer_load_dwordx4 v7, s[32:35], s50 offen lds
    s_mov_b64 exec, -1
    s_mov_b32 s40, s22
    s_mov_b32 s41, s23
    s_mov_b32 s42, 256
    s_mov_b32 s43, 0x20000
    v_min_u32 v20, 19, v1
    v_lshlrev_b32 v20, 2, v20
    buffer_load_dword v21, v20, s[40:43], 0 offen sc1
    s_waitcnt vmcnt(10) lgkmcnt(0)
    s_barrier
    s_add_u32 m0, s55, 114688
    s_nop 0
    buffer_load_dwordx4 v2, s[28:31], s54 offen lds
    s_add_u32 m0, s55, 115712
    s_nop 0
    buffer_load_dwordx4 v3, s[28:31], s54 offen lds
    s_add_u32 m0, s55, 116736
    s_nop 0
    buffer_load_dwordx4 v4, s[28:31], s54 offen lds
    s_add_u32 m0, s55, 117760
    s_nop 0
    buffer_load_dwordx4 v5, s[28:31], s54 offen lds
    s_add_u32 s54, s54, 128
    s_cmp_eq_u32 s54, 896
    s_cselect_b32 s54, 0, s54
    s_mul_i32 s50, s51, s49
    s_add_u32 s50, s50, s52
    s_add_u32 s51, s51, 64
    s_cmp_eq_u32 s51, 448
    s_cselect_b32 s51, 0, s51
    s_mov_b64 exec, s[96:97]
    s_add_u32 m0, s55, 98304
    s_nop 0
    buffer_load_dwordx4 v7, s[32:35], s50 offen lds
    s_add_u32 m0, s55, 99328
    s_add_u32 s50, s50, s53
    buffer_load_dwordx4 v7, s[32:35], s50 offen lds
    s_add_u32 m0, s55, 100352
    s_add_u32 s50, s50, s53
    buffer_load_dwordx4 v7, s[32:35], s50 offen lds
    s_add_u32 m0, s55, 101376
    s_add_u32 s50, s50, s53
    buffer_load_dwordx4 v7, s[32:35], s50 offen lds
    s_mov_b64 exec, -1
    s_lshr_b32 s52, s46, 1
    s_xor_b32 s52, s52, s2
    s_and_b32 s52, s52, 1
    v_lshrrev_b32 v8, 2, v1
    v_mul_u32_u24 v8, 896, v8
    v_bfe_u32 v9, v1, 4, 2
    v_and_b32 v10, 3, v1
    v_xor_b32 v9, v9, v10
    v_lshl_add_u32 v8, v9, 4, v8
    s_mul_i32 s3, s48, 28672
    s_lshl_b32 s26, s45, 7
    s_add_u32 s3, s3, s26
    s_lshl_b32 s26, s52, 6
    s_add_u32 s3, s3, s26
    s_add_u32 s26, s3, 14336
    buffer_load_dwordx4 v[232:235], v8, s[28:31], s3 offen
    buffer_load_dwordx4 v[236:239], v8, s[28:31], s26 offen
    s_mov_b32 s40, s16
    s_mov_b32 s41, s17
    s_mov_b32 s42, 1605632
    s_mov_b32 s43, 0x20000
    s_mul_i32 s3, s2, 2341
    s_lshr_b32 s3, s3, 16
    s_mul_i32 s57, s3, 28
    s_sub_u32 s57, s2, s57
    s_lshl_b32 s3, s3, 2
    s_add_u32 s3, s3, s46
    s_mul_i32 s63, s57, 28
    s_add_u32 s63, s63, s3
    s_lshl_b32 s63, s63, 8
    s_add_u32 s63, s63, 8388608
    s_cmp_lt_u32 s2, 196
    s_cselect_b32 s63, s63, 2147483648
    s_mul_i32 s3, s3, 57344
    s_lshl_b32 s57, s57, 7
    s_add_u32 s3, s3, s57
    s_add_u32 s57, s3, 28672
    v_lshrrev_b32 v8, 3, v1
    v_mul_u32_u24 v8, 3584, v8
    v_and_b32 v9, 7, v1
    v_lshl_add_u32 v8, v9, 4, v8
    buffer_load_dwordx4 v[32:35], v8, s[40:43], s3 offen
    buffer_load_dwordx4 v[36:39], v8, s[40:43], s57 offen
    s_mov_b32 s40, s16
    s_mov_b32 s41, s17
    s_mov_b32 s42, 1605632
    s_mov_b32 s43, 0x20000
    s_lshr_b32 s57, s2, 3
    s_lshl_b32 s57, s57, 2
    s_add_u32 s57, s57, s46
    s_mul_i32 s3, s57, 49
    v_add_u32 v9, s3, v1
    v_mul_u32_u24 v10, 9363, v9
    v_lshrrev_b32 v10, 17, v10
    v_mul_u32_u24 v11, 14, v10
    v_sub_u32 v9, v9, v11
    v_mul_u32_u24 v10, 3584, v10
    v_lshl_add_u32 v9, v9, 7, v10
    s_and_b32 s3, s2, 1
    s_mul_i32 s3, s3, 1792
    s_bfm_b64 exec, 49, 0
    buffer_load_dword v17, v9, s[40:43], s3 offen
    s_mov_b64 exec, -1
    s_mov_b32 s40, s18
    s_mov_b32 s41, s19
    s_mov_b32 s42, 1605632
    s_mov_b32 s43, 0x20000
    v_lshlrev_b32 v8, 7, v1
    s_lshl_b32 s57, s2, 2
    s_add_u32 s57, s57, s46
    s_mul_i32 s3, s57, 1664
    s_bfm_b64 exec, 13, 0
    buffer_load_dword v18, v8, s[40:43], s3 offen
    s_mov_b32 s40, s8
    s_mov_b32 s41, s9
    s_mov_b32 s42, 401408
    s_mov_b32 s43, 0x20000
    s_lshl_b32 s3, s57, 9
    s_mov_b64 exec, 15
    buffer_load_dword v19, v8, s[40:43], s3 offen
    s_mov_b64 exec, -1
    s_waitcnt vmcnt(15) lgkmcnt(0)
    s_barrier
    v_cmp_eq_u32 vcc, 0, v21
    s_nop 1
    s_cbranch_vccz PB_clr
    s_mov_b32 s40, s22
    s_mov_b32 s41, s23
    s_mov_b32 s42, 256
    s_mov_b32 s43, 0x20000
    s_mov_b32 s58, 65536
    s_bfm_b64 exec, 20, 0
PL_1:
    buffer_load_dword v9, v20, s[40:43], 0 offen sc1
    s_waitcnt vmcnt(0)
    v_cmp_eq_u32 vcc, 0, v9
    s_nop 1
    s_cbranch_vccz PD_2
    s_sleep 1
    s_sub_u32 s58, s58, 1
    s_cmp_lg_u32 s58, 0
    s_cbranch_scc1 PL_1
PD_2:
    s_mov_b64 exec, -1
PB_clr:
    s_waitcnt vmcnt(7) lgkmcnt(0)
    s_barrier
    v_mov_b32 v8, 159744
    v_mov_b32 v12, 0
    v_mov_b32 v13, 0
    v_mov_b32 v14, 0
    v_mov_b32 v15, 0
    ds_write_b128 v8, v[12:15]
    ds_write_b128 v8, v[12:15] offset:16
    ds_write_b128 v8, v[12:15] offset:32
    s_waitcnt lgkmcnt(0)
    s_barrier
    s_waitcnt vmcnt(3)
    v_lshlrev_b32 v40, 16, v32
    v_and_b32 v41, 0xffff0000, v32
    v_lshlrev_b32 v42, 16, v33
    v_and_b32 v43, 0xffff0000, v33
    v_lshlrev_b32 v44, 16, v34
    v_and_b32 v45, 0xffff0000, v34
    v_lshlrev_b32 v46, 16, v35
    v_and_b32 v47, 0xffff0000, v35
    v_lshlrev_b32 v48, 16, v36
    v_and_b32 v49, 0xffff0000, v36
    v_lshlrev_b32 v50, 16, v37
    v_and_b32 v51, 0xffff0000, v37
    v_lshlrev_b32 v52, 16, v38
    v_and_b32 v53, 0xffff0000, v38
    v_lshlrev_b32 v54, 16, v39
    v_and_b32 v55, 0xffff0000, v39
    v_add_f32 v40, v40, v48
    v_add_f32 v41, v41, v49
    v_add_f32 v42, v42, v50
    v_add_f32 v43, v43, v51
    v_add_f32 v44, v44, v52
    v_add_f32 v45, v45, v53
    v_add_f32 v46, v46, v54
    v_add_f32 v47, v47, v55
    v_permlane32_swap_b32 v40, v44
    v_permlane32_swap_b32 v41, v45
    v_permlane32_swap_b32 v42, v46
    v_permlane32_swap_b32 v43, v47
    v_add_f32 v40, v40, v44
    v_add_f32 v41, v41, v45
    v_add_f32 v42, v42, v46
    v_add_f32 v43, v43, v47
    s_nop 0
    v_permlane16_swap_b32 v40, v42
    v_permlane16_swap_b32 v41, v43
    v_add_f32 v40, v40, v42
    v_add_f32 v41, v41, v43
    v_and_b32 v8, 7, v1
    v_lshrrev_b32 v9, 4, v1
    v_lshlrev_b32 v8, 5, v8
    v_lshl_add_u32 v8, v9, 3, v8
    v_add_f32_dpp v40, v40, v40 row_ror:8 row_mask:0xf bank_mask:0xf
    v_add_f32_dpp v41, v41, v41 row_ror:8 row_mask:0xf bank_mask:0xf
    buffer_store_dwordx2 v[40:41], v8, s[36:39], s63 offen sc1
    s_lshl_b32 s49, s46, 11
    s_add_u32 s3, s49, 57344
    v_add_u32 v10, s3, v0
    v_and_b32 v8, 31, v1
    v_lshlrev_b32 v8, 6, v8
    v_bfe_u32 v9, v1, 2, 2
    v_lshl_add_u32 v8, v9, 4, v8
    v_lshrrev_b32 v9, 5, v1
    v_lshl_add_u32 v8, v9, 3, v8
    v_add_u32 v12, s3, v8
    v_xor_b32 v13, 16, v12
    v_xor_b32 v14, 32, v12
    v_xor_b32 v15, 48, v12
    ds_write_b128 v10, v[232:235]
    ds_write_b128 v10, v[236:239] offset:1024
    s_waitcnt lgkmcnt(0)
    ds_read_b64 v[176:177], v12
    ds_read_b64 v[178:179], v13
    ds_read_b64 v[180:181], v14
    ds_read_b64 v[182:183], v15
    s_and_b32 s26, s2, 7
    s_lshr_b32 s27, s2, 3
    s_lshr_b32 s54, s26, 1
    s_lshl_b32 s54, s54, 2
    s_and_b32 s3, s27, 3
    s_add_u32 s54, s54, s3
    s_and_b32 s55, s26, 1
    s_mul_i32 s55, s55, 7
    s_add_u32 s55, s55, s45
    s_lshl_b32 s56, s54, 2
    s_add_u32 s56, s56, s46
    v_lshrrev_b32 v8, 3, v1
    v_bfe_u32 v9, v1, 4, 1
    v_lshlrev_b32 v9, 2, v9
    v_and_b32 v6, 7, v1
    v_xor_b32 v9, v9, v6
    v_mul_u32_u24 v8, 3584, v8
    v_lshl_add_u32 v6, v9, 4, v8
    s_mul_i32 s3, s46, 57344
    s_lshl_b32 s26, s55, 8
    s_add_u32 s3, s3, s26
    v_add_u32 v6, s3, v6
    s_mul_i32 s57, s45, 229376
    s_mov_b32 s40, s16
    s_mov_b32 s41, s17
    s_mov_b32 s42, 1605632
    s_mov_b32 s43, 0x20000
    s_waitcnt lgkmcnt(0)
    s_mul_i32 s3, s48, 28
    s_mul_i32 s26, s52, 14
    s_add_u32 s3, s3, s26
    s_lshl_b32 s3, s3, 10
    s_add_u32 s3, s3, 6291456
    v_add_u32 v186, s3, v0
    v_add_u32 v187, 7168, v186
    s_mul_i32 s51, s45, 1024
    s_mul_i32 s53, s48, 28
    s_lshl_b32 s3, s45, 2
    s_add_u32 s53, s53, s3
    s_lshl_b32 s3, s52, 1
    s_add_u32 s53, s53, s3
    s_lshl_b32 s53, s53, 10
    s_add_u32 s53, s53, 10485760
    s_lshl_b32 s3, s52, 1
    s_add_u32 s3, s3, 12
    s_lshl_b32 s3, s3, 4
    s_lshr_b32 s26, s44, 1
    s_add_u32 s3, s3, s26
    s_lshl_b32 s3, s3, 7
    s_add_u32 s3, s3, 22347776
    v_lshl_add_u32 v188, v1, 11, s3
    s_lshl_b32 s3, s26, 7
    s_add_u32 s3, s3, 22347776
    v_mov_b32 v189, s3
    v_lshlrev_b32 v8, 3, v1
    v_and_b32 v15, 0xff, v8
    s_lshl_b32 s27, s48, 8
    s_add_u32 s27, s27, 22020096
    v_lshlrev_b32 v224, 16, v176
    v_and_b32 v225, 0xffff0000, v176
    v_lshlrev_b32 v226, 16, v177
    v_and_b32 v227, 0xffff0000, v177
    v_lshlrev_b32 v228, 16, v178
    v_and_b32 v229, 0xffff0000, v178
    v_lshlrev_b32 v230, 16, v179
    v_and_b32 v231, 0xffff0000, v179
    v_lshlrev_b32 v232, 16, v180
    v_and_b32 v233, 0xffff0000, v180
    v_lshlrev_b32 v234, 16, v181
    v_and_b32 v235, 0xffff0000, v181
    v_lshlrev_b32 v236, 16, v182
    v_and_b32 v237, 0xffff0000, v182
    v_lshlrev_b32 v238, 16, v183
    v_and_b32 v239, 0xffff0000, v183
    s_lshl_b32 s26, s46, 12
    s_add_u32 s26, s26, 131072
    v_add_u32 v190, s26, v0
    v_xor_b32 v191, 8192, v190
    s_lshl_b32 s26, s45, 1
    s_add_u32 s26, s26, s52
    s_mul_i32 s62, s48, 14
    s_add_u32 s62, s62, s26
    s_lshl_b32 s62, s62, 8
    s_add_u32 s62, s62, 22085632
    s_lshl_b32 s63, s44, 3
    s_add_u32 s63, s63, s45
    s_lshl_b32 s63, s63, 7
    s_add_u32 s63, s63, 22380544
    s_and_b32 s3, s2, 1
    s_lshl_b32 s3, s3, 3
    s_lshr_b32 s26, s2, 5
    s_add_u32 s3, s3, s26
    s_lshl_b32 s3, s3, 4
    s_lshr_b32 s26, s44, 1
    s_add_u32 s3, s3, s26
    s_lshl_b32 s3, s3, 7
    s_add_u32 s3, s3, 22347776
    s_waitcnt vmcnt(0)
    s_mov_b64 exec, 1
    v_mov_b32 v8, 159752
    v_mov_b32 v9, 1
    ds_add_rtn_u32 v8, v8, v9
    s_waitcnt lgkmcnt(0)
    v_readfirstlane_b32 s26, v8
    v_mov_b32 v8, 0
    s_nop 0
    s_cmp_eq_u32 s26, 7
    s_cselect_b32 s26, s3, 2147483648
    s_nop 0
    buffer_store_dword v9, v8, s[36:39], s26 offen sc1
    s_mov_b64 exec, -1
    s_mov_b32 s58, 524288
    v_mov_b32 v8, 159772
GL_3:
    ds_read_b32 v9, v8
    s_sub_u32 s58, s58, 1
    s_cbranch_scc1 GD_4
    s_waitcnt lgkmcnt(0)
    v_readfirstlane_b32 s3, v9
    s_nop 1
    s_bfe_u32 s3, s3, 262148
    s_cmp_lt_u32 s3, 4
    s_cbranch_scc1 GL_3
GD_4:
    s_waitcnt lgkmcnt(0)
    s_mov_b32 s58, 524288
    v_mov_b32 v8, 159752
GL_5:
    ds_read_b32 v9, v8
    s_sub_u32 s58, s58, 1
    s_cbranch_scc1 GD_6
    s_waitcnt lgkmcnt(0)
    v_readfirstlane_b32 s3, v9
    s_nop 1
    s_cmp_lt_u32 s3, 8
    s_cbranch_scc1 GL_5
GD_6:
    s_waitcnt lgkmcnt(0)
    s_lshl_b32 s47, s46, 11
    v_lshrrev_b32 v8, 3, v1
    v_bfe_u32 v9, v1, 4, 1
    v_lshlrev_b32 v9, 2, v9
    v_and_b32 v10, 7, v1
    v_xor_b32 v9, v9, v10
    v_mul_u32_u24 v8, 896, v8
    v_lshl_add_u32 v7, v9, 4, v8
    v_lshrrev_b32 v8, 5, v1
    v_bfe_u32 v9, v1, 2, 2
    v_lshl_add_u32 v8, v8, 2, v9
    v_lshlrev_b32 v8, 7, v8
    v_bfe_u32 v10, v1, 4, 1
    v_bfe_u32 v11, v1, 1, 1
    v_lshl_add_u32 v10, v10, 1, v11
    v_bfe_u32 v11, v1, 3, 1
    v_lshl_add_u32 v10, v11, 2, v10
    v_lshl_add_u32 v8, v10, 4, v8
    v_and_b32 v11, 1, v1
    v_lshl_add_u32 v8, v11, 3, v8
    s_lshl_b32 s3, s52, 6
    v_xor_b32 v8, s3, v8
    v_add_u32 v2, s47, v8
    v_xor_b32 v8, 64, v8
    v_add_u32 v3, s47, v8
    s_mov_b32 s32, s14
    s_mov_b32 s33, s15
    s_mov_b32 s34, 401408
    s_mov_b32 s35, 0x20000
    s_mul_i32 s3, s46, 100352
    s_lshl_b32 s26, s45, 7
    s_add_u32 s3, s3, s26
    v_add_u32 v4, s3, v7
    v_add_u32 v5, 7168, v4
    s_mul_i32 s50, s45, 14336
    s_add_u32 m0, s47, 0
    s_nop 0
    buffer_load_dwordx4 v4, s[32:35], s50 offen lds
    s_add_u32 m0, s47, 1024
    s_nop 0
    buffer_load_dwordx4 v5, s[32:35], s50 offen lds
    s_add_u32 s50, s50, 14336
    s_cmp_eq_u32 s50, 100352
    s_cselect_b32 s50, 0, s50
    s_add_u32 m0, s47, 8192
    s_nop 0
    buffer_load_dwordx4 v4, s[32:35], s50 offen lds
    s_add_u32 m0, s47, 9216
    s_nop 0
    buffer_load_dwordx4 v5, s[32:35], s50 offen lds
    s_add_u32 s50, s50, 14336
    s_cmp_eq_u32 s50, 100352
    s_cselect_b32 s50, 0, s50
    s_add_u32 m0, s47, 16384
    s_nop 0
    buffer_load_dwordx4 v4, s[32:35], s50 offen lds
    s_add_u32 m0, s47, 17408
    s_nop 0
    buffer_load_dwordx4 v5, s[32:35], s50 offen lds
    s_add_u32 s50, s50, 14336
    s_cmp_eq_u32 s50, 100352
    s_cselect_b32 s50, 0, s50
    s_add_u32 m0, s47, 24576
    s_nop 0
    buffer_load_dwordx4 v4, s[32:35], s50 offen lds
    s_add_u32 m0, s47, 25600
    s_nop 0
    buffer_load_dwordx4 v5, s[32:35], s50 offen lds
    s_add_u32 s50, s50, 14336
    s_cmp_eq_u32 s50, 100352
    s_cselect_b32 s50, 0, s50
    s_add_u32 m0, s47, 32768
    s_nop 0
    buffer_load_dwordx4 v4, s[32:35], s50 offen lds
    s_add_u32 m0, s47, 33792
    s_nop 0
    buffer_load_dwordx4 v5, s[32:35], s50 offen lds
    s_add_u32 s50, s50, 14336
    s_cmp_eq_u32 s50, 100352
    s_cselect_b32 s50, 0, s50
    s_add_u32 m0, s47, 40960
    s_nop 0
    buffer_load_dwordx4 v4, s[32:35], s50 offen lds
    s_add_u32 m0, s47, 41984
    s_nop 0
    buffer_load_dwordx4 v5, s[32:35], s50 offen lds
    s_add_u32 s50, s50, 14336
    s_cmp_eq_u32 s50, 100352
    s_cselect_b32 s50, 0, s50
    s_add_u32 m0, s47, 49152
    s_nop 0
    buffer_load_dwordx4 v4, s[32:35], s50 offen lds
    s_add_u32 m0, s47, 50176
    s_nop 0
    buffer_load_dwordx4 v5, s[32:35], s50 offen lds
    s_branch K_roleb
K_rolea:
    s_setprio 2
    s_and_b32 s26, s2, 7
    s_lshr_b32 s27, s2, 3
    s_lshr_b32 s44, s26, 1
    s_lshl_b32 s44, s44, 2
    s_and_b32 s3, s27, 3
    s_add_u32 s44, s44, s3
    s_and_b32 s45, s26, 1
    s_lshl_b32 s45, s45, 3
    s_lshr_b32 s3, s27, 2
    s_add_u32 s45, s45, s3
    s_lshr_b32 s47, s45, 2
    s_and_b32 s48, s45, 3
    s_cmp_eq_u32 s47, 3
    s_cselect_b32 s50, 8, 7
    s_cselect_b32 s55, -1, 0
    s_lshl_b32 s56, s44, 2
    s_add_u32 s56, s56, s46
    v_lshrrev_b32 v8, 5, v1
    v_bfe_u32 v9, v1, 2, 2
    v_bfe_u32 v10, v1, 4, 1
    v_and_b32 v11, 3, v1
    v_lshl_add_u32 v10, v10, 2, v11
    v_lshl_add_u32 v8, v8, 3, v9
    v_lshlrev_b32 v8, 8, v8
    v_add_u32 v8, 0, v8
    v_lshlrev_b32 v9, 2, v9
    s_mul_i32 s26, s50, 0
    v_add_u32 v11, s26, v10
    v_lshrrev_b32 v12, 1, v11
    v_add_u32 v12, v12, v9
    v_and_b32 v12, 15, v12
    v_and_b32 v11, 1, v11
    v_lshlrev_b32 v11, 3, v11
    v_lshl_add_u32 v11, v12, 4, v11
    v_add_u32 v2, v8, v11
    s_mul_i32 s26, s50, 1
    v_add_u32 v11, s26, v10
    v_lshrrev_b32 v12, 1, v11
    v_add_u32 v12, v12, v9
    v_and_b32 v12, 15, v12
    v_and_b32 v11, 1, v11
    v_lshlrev_b32 v11, 3, v11
    v_lshl_add_u32 v11, v12, 4, v11
    v_add_u32 v3, v8, v11
    s_mul_i32 s26, s50, 2
    v_add_u32 v11, s26, v10
    v_lshrrev_b32 v12, 1, v11
    v_add_u32 v12, v12, v9
    v_and_b32 v12, 15, v12
    v_and_b32 v11, 1, v11
    v_lshlrev_b32 v11, 3, v11
    v_lshl_add_u32 v11, v12, 4, v11
    v_add_u32 v4, v8, v11
    s_mul_i32 s26, s50, 3
    v_add_u32 v11, s26, v10
    v_lshrrev_b32 v12, 1, v11
    v_add_u32 v12, v12, v9
    v_and_b32 v12, 15, v12
    v_and_b32 v11, 1, v11
    v_lshlrev_b32 v11, 3, v11
    v_lshl_add_u32 v11, v12, 4, v11
    v_add_u32 v5, v8, v11
    s_mul_i32 s26, s50, s46
    v_add_u32 v11, s26, v10
    v_lshrrev_b32 v12, 1, v11
    v_add_u32 v12, v12, v9
    v_and_b32 v12, 15, v12
    v_and_b32 v11, 1, v11
    v_lshlrev_b32 v11, 3, v11
    v_lshl_add_u32 v11, v12, 4, v11
    v_add_u32 v6, v8, v11
    v_and_b32 v8, 15, v1
    v_bfe_u32 v9, v1, 4, 1
    v_cmp_eq_u32 vcc, v8, v9
    v_mov_b32 v8, 0x3f803f80
    s_nop 0
    v_cndmask_b32 v84, 0, v8, vcc
    v_mov_b32 v85, v84
    v_mov_b32 v86, v84
    v_mov_b32 v87, v84
    v_and_b32 v8, 31, v1
    v_lshrrev_b32 v9, 5, v1
    v_bfe_u32 v10, v1, 1, 3
    v_xor_b32 v9, v9, v10
    v_lshlrev_b32 v8, 7, v8
    v_lshl_add_u32 v8, v9, 4, v8
    s_lshl_b32 s3, s46, 12
    s_add_u32 s3, s3, 114688
    v_add_u32 v88, s3, v8
    v_xor_b32 v89, 32, v88
    v_xor_b32 v90, 64, v88
    v_xor_b32 v91, 96, v88
    s_waitcnt lgkmcnt(0)
    s_mov_b32 s36, s24
    s_mov_b32 s37, s25
    s_mov_b32 s38, 27262976
    s_mov_b32 s39, 0x20000
    v_and_b32 v10, 31, v1
    v_lshlrev_b32 v10, 2, v10
    v_add_u32 v10, 131072, v10
    s_barrier
    ds_read_b128 v[136:139], v88 offset:0
    ds_read_b128 v[140:143], v89 offset:0
    ds_read_b128 v[144:147], v90 offset:0
    ds_read_b128 v[148:151], v91 offset:0
    ds_read_b64_tr_b16 v[96:97], v2 offset:0
    ds_read_b64_tr_b16 v[98:99], v2 offset:1024
    ds_read_b64_tr_b16 v[100:101], v6 offset:0
    ds_read_b64_tr_b16 v[102:103], v6 offset:1024
    ds_read_b64_tr_b16 v[104:105], v3 offset:0
    ds_read_b64_tr_b16 v[106:107], v3 offset:1024
    ds_read_b64_tr_b16 v[108:109], v4 offset:0
    ds_read_b64_tr_b16 v[110:111], v4 offset:1024
    ds_read_b64_tr_b16 v[112:113], v5 offset:0
    ds_read_b64_tr_b16 v[114:115], v5 offset:1024
    s_waitcnt lgkmcnt(8)
    v_mfma_f32_32x32x16_bf16 v[16:31], v[96:99], v[136:139], 0
    ds_read_b64_tr_b16 v[116:117], v2 offset:4096
    ds_read_b64_tr_b16 v[118:119], v2 offset:5120
    v_dot2_f32_bf16 v12, v136, v136, 0
    v_dot2_f32_bf16 v13, v137, v137, 0
    v_dot2_f32_bf16 v12, v138, v138, v12
    v_dot2_f32_bf16 v13, v139, v139, v13
    v_dot2_f32_bf16 v12, v140, v140, v12
    v_dot2_f32_bf16 v13, v141, v141, v13
    v_dot2_f32_bf16 v12, v142, v142, v12
    v_dot2_f32_bf16 v13, v143, v143, v13
    v_dot2_f32_bf16 v12, v144, v144, v12
    v_dot2_f32_bf16 v13, v145, v145, v13
    v_dot2_f32_bf16 v12, v146, v146, v12
    v_dot2_f32_bf16 v13, v147, v147, v13
    v_dot2_f32_bf16 v12, v148, v148, v12
    v_dot2_f32_bf16 v13, v149, v149, v13
    v_dot2_f32_bf16 v12, v150, v150, v12
    v_dot2_f32_bf16 v13, v151, v151, v13
    s_waitcnt lgkmcnt(8)
    v_mfma_f32_16x16x32_bf16 v[80:83], v[84:87], v[100:103], 0
    ds_read_b64_tr_b16 v[120:121], v6 offset:4096
    ds_read_b64_tr_b16 v[122:123], v6 offset:5120
    s_waitcnt lgkmcnt(8)
    v_mfma_f32_32x32x16_bf16 v[32:47], v[104:107], v[136:139], 0
    ds_read_b64_tr_b16 v[124:125], v3 offset:4096
    ds_read_b64_tr_b16 v[126:127], v3 offset:5120
    s_waitcnt lgkmcnt(8)
    v_mfma_f32_32x32x16_bf16 v[48:63], v[108:111], v[136:139], 0
    ds_read_b64_tr_b16 v[96:97], v4 offset:4096
    ds_read_b64_tr_b16 v[98:99], v4 offset:5120
    s_waitcnt lgkmcnt(8)
    v_mfma_f32_32x32x16_bf16 v[64:79], v[112:115], v[136:139], 0
    ds_read_b64_tr_b16 v[100:101], v5 offset:4096
    ds_read_b64_tr_b16 v[102:103], v5 offset:5120
    s_waitcnt lgkmcnt(8)
    v_mfma_f32_32x32x16_bf16 v[16:31], v[116:119], v[140:143], v[16:31]
    ds_read_b64_tr_b16 v[104:105], v2 offset:8192
    ds_read_b64_tr_b16 v[106:107], v2 offset:9216
    s_waitcnt lgkmcnt(8)
    v_mfma_f32_16x16x32_bf16 v[80:83], v[84:87], v[120:123], v[80:83]
    ds_read_b64_tr_b16 v[108:109], v6 offset:8192
    ds_read_b64_tr_b16 v[110:111], v6 offset:9216
    s_waitcnt lgkmcnt(8)
    v_mfma_f32_32x32x16_bf16 v[32:47], v[124:127], v[140:143], v[32:47]
    ds_read_b64_tr_b16 v[112:113], v3 offset:8192
    ds_read_b64_tr_b16 v[114:115], v3 offset:9216
    s_waitcnt lgkmcnt(8)
    v_mfma_f32_32x32x16_bf16 v[48:63], v[96:99], v[140:143], v[48:63]
    ds_read_b64_tr_b16 v[116:117], v4 offset:8192
    ds_read_b64_tr_b16 v[118:119], v4 offset:9216
    s_waitcnt lgkmcnt(8)
    v_mfma_f32_32x32x16_bf16 v[64:79], v[100:103], v[140:143], v[64:79]
    ds_read_b64_tr_b16 v[120:121], v5 offset:8192
    ds_read_b64_tr_b16 v[122:123], v5 offset:9216
    s_waitcnt lgkmcnt(8)
    v_mfma_f32_32x32x16_bf16 v[16:31], v[104:107], v[144:147], v[16:31]
    ds_read_b64_tr_b16 v[124:125], v2 offset:12288
    ds_read_b64_tr_b16 v[126:127], v2 offset:13312
    s_waitcnt lgkmcnt(8)
    v_mfma_f32_16x16x32_bf16 v[80:83], v[84:87], v[108:111], v[80:83]
    ds_read_b64_tr_b16 v[96:97], v6 offset:12288
    ds_read_b64_tr_b16 v[98:99], v6 offset:13312
    s_waitcnt lgkmcnt(8)
    v_mfma_f32_32x32x16_bf16 v[32:47], v[112:115], v[144:147], v[32:47]
    ds_read_b64_tr_b16 v[100:101], v3 offset:12288
    ds_read_b64_tr_b16 v[102:103], v3 offset:13312
    s_waitcnt lgkmcnt(8)
    v_mfma_f32_32x32x16_bf16 v[48:63], v[116:119], v[144:147], v[48:63]
    ds_read_b64_tr_b16 v[104:105], v4 offset:12288
    ds_read_b64_tr_b16 v[106:107], v4 offset:13312
    s_waitcnt lgkmcnt(8)
    v_mfma_f32_32x32x16_bf16 v[64:79], v[120:123], v[144:147], v[64:79]
    ds_read_b64_tr_b16 v[108:109], v5 offset:12288
    ds_read_b64_tr_b16 v[110:111], v5 offset:13312
    s_waitcnt lgkmcnt(8)
    v_mfma_f32_32x32x16_bf16 v[16:31], v[124:127], v[148:151], v[16:31]
    s_barrier
    ds_read_b128 v[152:155], v88 offset:16384
    ds_read_b128 v[156:159], v89 offset:16384
    ds_read_b128 v[160:163], v90 offset:16384
    ds_read_b128 v[164:167], v91 offset:16384
    ds_read_b64_tr_b16 v[112:113], v2 offset:16384
    ds_read_b64_tr_b16 v[114:115], v2 offset:17408
    s_waitcnt lgkmcnt(8)
    v_mfma_f32_16x16x32_bf16 v[80:83], v[84:87], v[96:99], v[80:83]
    ds_read_b64_tr_b16 v[116:117], v6 offset:16384
    ds_read_b64_tr_b16 v[118:119], v6 offset:17408
    s_waitcnt lgkmcnt(8)
    v_mfma_f32_32x32x16_bf16 v[32:47], v[100:103], v[148:151], v[32:47]
    ds_read_b64_tr_b16 v[120:121], v3 offset:16384
    ds_read_b64_tr_b16 v[122:123], v3 offset:17408
    s_waitcnt lgkmcnt(8)
    v_mfma_f32_32x32x16_bf16 v[48:63], v[104:107], v[148:151], v[48:63]
    ds_read_b64_tr_b16 v[124:125], v4 offset:16384
    ds_read_b64_tr_b16 v[126:127], v4 offset:17408
    s_waitcnt lgkmcnt(8)
    v_mfma_f32_32x32x16_bf16 v[64:79], v[108:111], v[148:151], v[64:79]
    ds_read_b64_tr_b16 v[96:97], v5 offset:16384
    ds_read_b64_tr_b16 v[98:99], v5 offset:17408
    s_waitcnt lgkmcnt(8)
    v_mfma_f32_32x32x16_bf16 v[16:31], v[112:115], v[152:155], v[16:31]
    ds_read_b64_tr_b16 v[100:101], v2 offset:20480
    ds_read_b64_tr_b16 v[102:103], v2 offset:21504
    v_dot2_f32_bf16 v12, v152, v152, v12
    v_dot2_f32_bf16 v13, v153, v153, v13
    v_dot2_f32_bf16 v12, v154, v154, v12
    v_dot2_f32_bf16 v13, v155, v155, v13
    v_dot2_f32_bf16 v12, v156, v156, v12
    v_dot2_f32_bf16 v13, v157, v157, v13
    v_dot2_f32_bf16 v12, v158, v158, v12
    v_dot2_f32_bf16 v13, v159, v159, v13
    v_dot2_f32_bf16 v12, v160, v160, v12
    v_dot2_f32_bf16 v13, v161, v161, v13
    v_dot2_f32_bf16 v12, v162, v162, v12
    v_dot2_f32_bf16 v13, v163, v163, v13
    v_dot2_f32_bf16 v12, v164, v164, v12
    v_dot2_f32_bf16 v13, v165, v165, v13
    v_dot2_f32_bf16 v12, v166, v166, v12
    v_dot2_f32_bf16 v13, v167, v167, v13
    s_waitcnt lgkmcnt(8)
    v_mfma_f32_16x16x32_bf16 v[80:83], v[84:87], v[116:119], v[80:83]
    ds_read_b64_tr_b16 v[104:105], v6 offset:20480
    ds_read_b64_tr_b16 v[106:107], v6 offset:21504
    s_waitcnt lgkmcnt(8)
    v_mfma_f32_32x32x16_bf16 v[32:47], v[120:123], v[152:155], v[32:47]
    ds_read_b64_tr_b16 v[108:109], v3 offset:20480
    ds_read_b64_tr_b16 v[110:111], v3 offset:21504
    s_waitcnt lgkmcnt(8)
    v_mfma_f32_32x32x16_bf16 v[48:63], v[124:127], v[152:155], v[48:63]
    ds_read_b64_tr_b16 v[112:113], v4 offset:20480
    ds_read_b64_tr_b16 v[114:115], v4 offset:21504
    s_waitcnt lgkmcnt(8)
    v_mfma_f32_32x32x16_bf16 v[64:79], v[96:99], v[152:155], v[64:79]
    ds_read_b64_tr_b16 v[116:117], v5 offset:20480
    ds_read_b64_tr_b16 v[118:119], v5 offset:21504
    s_waitcnt lgkmcnt(8)
    v_mfma_f32_32x32x16_bf16 v[16:31], v[100:103], v[156:159], v[16:31]
    ds_read_b64_tr_b16 v[120:121], v2 offset:24576
    ds_read_b64_tr_b16 v[122:123], v2 offset:25600
    s_waitcnt lgkmcnt(8)
    v_mfma_f32_16x16x32_bf16 v[80:83], v[84:87], v[104:107], v[80:83]
    ds_read_b64_tr_b16 v[124:125], v6 offset:24576
    ds_read_b64_tr_b16 v[126:127], v6 offset:25600
    s_waitcnt lgkmcnt(8)
    v_mfma_f32_32x32x16_bf16 v[32:47], v[108:111], v[156:159], v[32:47]
    ds_read_b64_tr_b16 v[96:97], v3 offset:24576
    ds_read_b64_tr_b16 v[98:99], v3 offset:25600
    s_waitcnt lgkmcnt(8)
    v_mfma_f32_32x32x16_bf16 v[48:63], v[112:115], v[156:159], v[48:63]
    ds_read_b64_tr_b16 v[100:101], v4 offset:24576
    ds_read_b64_tr_b16 v[102:103], v4 offset:25600
    s_waitcnt lgkmcnt(8)
    v_mfma_f32_32x32x16_bf16 v[64:79], v[116:119], v[156:159], v[64:79]
    ds_read_b64_tr_b16 v[104:105], v5 offset:24576
    ds_read_b64_tr_b16 v[106:107], v5 offset:25600
    s_waitcnt lgkmcnt(8)
    v_mfma_f32_32x32x16_bf16 v[16:31], v[120:123], v[160:163], v[16:31]
    ds_read_b64_tr_b16 v[108:109], v2 offset:28672
    ds_read_b64_tr_b16 v[110:111], v2 offset:29696
    s_waitcnt lgkmcnt(8)
    v_mfma_f32_16x16x32_bf16 v[80:83], v[84:87], v[124:127], v[80:83]
    ds_read_b64_tr_b16 v[112:113], v6 offset:28672
    ds_read_b64_tr_b16 v[114:115], v6 offset:29696
    s_waitcnt lgkmcnt(8)
    v_mfma_f32_32x32x16_bf16 v[32:47], v[96:99], v[160:163], v[32:47]
    ds_read_b64_tr_b16 v[116:117], v3 offset:28672
    ds_read_b64_tr_b16 v[118:119], v3 offset:29696
    s_waitcnt lgkmcnt(8)
    v_mfma_f32_32x32x16_bf16 v[48:63], v[100:103], v[160:163], v[48:63]
    ds_read_b64_tr_b16 v[120:121], v4 offset:28672
    ds_read_b64_tr_b16 v[122:123], v4 offset:29696
    s_waitcnt lgkmcnt(8)
    v_mfma_f32_32x32x16_bf16 v[64:79], v[104:107], v[160:163], v[64:79]
    ds_read_b64_tr_b16 v[124:125], v5 offset:28672
    ds_read_b64_tr_b16 v[126:127], v5 offset:29696
    s_waitcnt lgkmcnt(8)
    v_mfma_f32_32x32x16_bf16 v[16:31], v[108:111], v[164:167], v[16:31]
    s_barrier
    ds_read_b128 v[136:139], v88 offset:32768
    ds_read_b128 v[140:143], v89 offset:32768
    ds_read_b128 v[144:147], v90 offset:32768
    ds_read_b128 v[148:151], v91 offset:32768
    ds_read_b64_tr_b16 v[96:97], v2 offset:32768
    ds_read_b64_tr_b16 v[98:99], v2 offset:33792
    s_waitcnt lgkmcnt(8)
    v_mfma_f32_16x16x32_bf16 v[80:83], v[84:87], v[112:115], v[80:83]
    ds_read_b64_tr_b16 v[100:101], v6 offset:32768
    ds_read_b64_tr_b16 v[102:103], v6 offset:33792
    s_waitcnt lgkmcnt(8)
    v_mfma_f32_32x32x16_bf16 v[32:47], v[116:119], v[164:167], v[32:47]
    ds_read_b64_tr_b16 v[104:105], v3 offset:32768
    ds_read_b64_tr_b16 v[106:107], v3 offset:33792
    s_waitcnt lgkmcnt(8)
    v_mfma_f32_32x32x16_bf16 v[48:63], v[120:123], v[164:167], v[48:63]
    ds_read_b64_tr_b16 v[108:109], v4 offset:32768
    ds_read_b64_tr_b16 v[110:111], v4 offset:33792
    s_waitcnt lgkmcnt(8)
    v_mfma_f32_32x32x16_bf16 v[64:79], v[124:127], v[164:167], v[64:79]
    ds_read_b64_tr_b16 v[112:113], v5 offset:32768
    ds_read_b64_tr_b16 v[114:115], v5 offset:33792
    s_waitcnt lgkmcnt(8)
    v_mfma_f32_32x32x16_bf16 v[16:31], v[96:99], v[136:139], v[16:31]
    ds_read_b64_tr_b16 v[116:117], v2 offset:36864
    ds_read_b64_tr_b16 v[118:119], v2 offset:37888
    v_dot2_f32_bf16 v12, v136, v136, v12
    v_dot2_f32_bf16 v13, v137, v137, v13
    v_dot2_f32_bf16 v12, v138, v138, v12
    v_dot2_f32_bf16 v13, v139, v139, v13
    v_dot2_f32_bf16 v12, v140, v140, v12
    v_dot2_f32_bf16 v13, v141, v141, v13
    v_dot2_f32_bf16 v12, v142, v142, v12
    v_dot2_f32_bf16 v13, v143, v143, v13
    v_dot2_f32_bf16 v12, v144, v144, v12
    v_dot2_f32_bf16 v13, v145, v145, v13
    v_dot2_f32_bf16 v12, v146, v146, v12
    v_dot2_f32_bf16 v13, v147, v147, v13
    v_dot2_f32_bf16 v12, v148, v148, v12
    v_dot2_f32_bf16 v13, v149, v149, v13
    v_dot2_f32_bf16 v12, v150, v150, v12
    v_dot2_f32_bf16 v13, v151, v151, v13
    s_waitcnt lgkmcnt(8)
    v_mfma_f32_16x16x32_bf16 v[80:83], v[84:87], v[100:103], v[80:83]
    ds_read_b64_tr_b16 v[120:121], v6 offset:36864
    ds_read_b64_tr_b16 v[122:123], v6 offset:37888
    s_waitcnt lgkmcnt(8)
    v_mfma_f32_32x32x16_bf16 v[32:47], v[104:107], v[136:139], v[32:47]
    ds_read_b64_tr_b16 v[124:125], v3 offset:36864
    ds_read_b64_tr_b16 v[126:127], v3 offset:37888
    s_waitcnt lgkmcnt(8)
    v_mfma_f32_32x32x16_bf16 v[48:63], v[108:111], v[136:139], v[48:63]
    ds_read_b64_tr_b16 v[96:97], v4 offset:36864
    ds_read_b64_tr_b16 v[98:99], v4 offset:37888
    s_waitcnt lgkmcnt(8)
    v_mfma_f32_32x32x16_bf16 v[64:79], v[112:115], v[136:139], v[64:79]
    ds_read_b64_tr_b16 v[100:101], v5 offset:36864
    ds_read_b64_tr_b16 v[102:103], v5 offset:37888
    s_waitcnt lgkmcnt(8)
    v_mfma_f32_32x32x16_bf16 v[16:31], v[116:119], v[140:143], v[16:31]
    ds_read_b64_tr_b16 v[104:105], v2 offset:40960
    ds_read_b64_tr_b16 v[106:107], v2 offset:41984
    s_waitcnt lgkmcnt(8)
    v_mfma_f32_16x16x32_bf16 v[80:83], v[84:87], v[120:123], v[80:83]
    ds_read_b64_tr_b16 v[108:109], v6 offset:40960
    ds_read_b64_tr_b16 v[110:111], v6 offset:41984
    s_waitcnt lgkmcnt(8)
    v_mfma_f32_32x32x16_bf16 v[32:47], v[124:127], v[140:143], v[32:47]
    ds_read_b64_tr_b16 v[112:113], v3 offset:40960
    ds_read_b64_tr_b16 v[114:115], v3 offset:41984
    s_waitcnt lgkmcnt(8)
    v_mfma_f32_32x32x16_bf16 v[48:63], v[96:99], v[140:143], v[48:63]
    ds_read_b64_tr_b16 v[116:117], v4 offset:40960
    ds_read_b64_tr_b16 v[118:119], v4 offset:41984
    s_waitcnt lgkmcnt(8)
    v_mfma_f32_32x32x16_bf16 v[64:79], v[100:103], v[140:143], v[64:79]
    ds_read_b64_tr_b16 v[120:121], v5 offset:40960
    ds_read_b64_tr_b16 v[122:123], v5 offset:41984
    s_waitcnt lgkmcnt(8)
    v_mfma_f32_32x32x16_bf16 v[16:31], v[104:107], v[144:147], v[16:31]
    ds_read_b64_tr_b16 v[124:125], v2 offset:45056
    ds_read_b64_tr_b16 v[126:127], v2 offset:46080
    s_waitcnt lgkmcnt(8)
    v_mfma_f32_16x16x32_bf16 v[80:83], v[84:87], v[108:111], v[80:83]
    ds_read_b64_tr_b16 v[96:97], v6 offset:45056
    ds_read_b64_tr_b16 v[98:99], v6 offset:46080
    s_waitcnt lgkmcnt(8)
    v_mfma_f32_32x32x16_bf16 v[32:47], v[112:115], v[144:147], v[32:47]
    ds_read_b64_tr_b16 v[100:101], v3 offset:45056
    ds_read_b64_tr_b16 v[102:103], v3 offset:46080
    s_waitcnt lgkmcnt(8)
    v_mfma_f32_32x32x16_bf16 v[48:63], v[116:119], v[144:147], v[48:63]
    ds_read_b64_tr_b16 v[104:105], v4 offset:45056
    ds_read_b64_tr_b16 v[106:107], v4 offset:46080
    s_waitcnt lgkmcnt(8)
    v_mfma_f32_32x32x16_bf16 v[64:79], v[120:123], v[144:147], v[64:79]
    ds_read_b64_tr_b16 v[108:109], v5 offset:45056
    ds_read_b64_tr_b16 v[110:111], v5 offset:46080
    s_waitcnt lgkmcnt(8)
    v_mfma_f32_32x32x16_bf16 v[16:31], v[124:127], v[148:151], v[16:31]
    s_barrier
    ds_read_b128 v[152:155], v88 offset:0
    ds_read_b128 v[156:159], v89 offset:0
    ds_read_b128 v[160:163], v90 offset:0
    ds_read_b128 v[164:167], v91 offset:0
    ds_read_b64_tr_b16 v[112:113], v2 offset:49152
    ds_read_b64_tr_b16 v[114:115], v2 offset:50176
    s_waitcnt lgkmcnt(8)
    v_mfma_f32_16x16x32_bf16 v[80:83], v[84:87], v[96:99], v[80:83]
    ds_read_b64_tr_b16 v[116:117], v6 offset:49152
    ds_read_b64_tr_b16 v[118:119], v6 offset:50176
    s_waitcnt lgkmcnt(8)
    v_mfma_f32_32x32x16_bf16 v[32:47], v[100:103], v[148:151], v[32:47]
    ds_read_b64_tr_b16 v[120:121], v3 offset:49152
    ds_read_b64_tr_b16 v[122:123], v3 offset:50176
    s_waitcnt lgkmcnt(8)
    v_mfma_f32_32x32x16_bf16 v[48:63], v[104:107], v[148:151], v[48:63]
    ds_read_b64_tr_b16 v[124:125], v4 offset:49152
    ds_read_b64_tr_b16 v[126:127], v4 offset:50176
    s_waitcnt lgkmcnt(8)
    v_mfma_f32_32x32x16_bf16 v[64:79], v[108:111], v[148:151], v[64:79]
    ds_read_b64_tr_b16 v[96:97], v5 offset:49152
    ds_read_b64_tr_b16 v[98:99], v5 offset:50176
    s_waitcnt lgkmcnt(8)
    v_mfma_f32_32x32x16_bf16 v[16:31], v[112:115], v[152:155], v[16:31]
    ds_read_b64_tr_b16 v[100:101], v2 offset:53248
    ds_read_b64_tr_b16 v[102:103], v2 offset:54272
    v_dot2_f32_bf16 v12, v152, v152, v12
    v_dot2_f32_bf16 v13, v153, v153, v13
    v_dot2_f32_bf16 v12, v154, v154, v12
    v_dot2_f32_bf16 v13, v155, v155, v13
    v_dot2_f32_bf16 v12, v156, v156, v12
    v_dot2_f32_bf16 v13, v157, v157, v13
    v_dot2_f32_bf16 v12, v158, v158, v12
    v_dot2_f32_bf16 v13, v159, v159, v13
    v_dot2_f32_bf16 v12, v160, v160, v12
    v_dot2_f32_bf16 v13, v161, v161, v13
    v_dot2_f32_bf16 v12, v162, v162, v12
    v_dot2_f32_bf16 v13, v163, v163, v13
    v_dot2_f32_bf16 v12, v164, v164, v12
    v_dot2_f32_bf16 v13, v165, v165, v13
    v_dot2_f32_bf16 v12, v166, v166, v12
    v_dot2_f32_bf16 v13, v167, v167, v13
    s_waitcnt lgkmcnt(8)
    v_mfma_f32_16x16x32_bf16 v[80:83], v[84:87], v[116:119], v[80:83]
    ds_read_b64_tr_b16 v[104:105], v6 offset:53248
    ds_read_b64_tr_b16 v[106:107], v6 offset:54272
    s_waitcnt lgkmcnt(8)
    v_mfma_f32_32x32x16_bf16 v[32:47], v[120:123], v[152:155], v[32:47]
    ds_read_b64_tr_b16 v[108:109], v3 offset:53248
    ds_read_b64_tr_b16 v[110:111], v3 offset:54272
    s_waitcnt lgkmcnt(8)
    v_mfma_f32_32x32x16_bf16 v[48:63], v[124:127], v[152:155], v[48:63]
    ds_read_b64_tr_b16 v[112:113], v4 offset:53248
    ds_read_b64_tr_b16 v[114:115], v4 offset:54272
    s_waitcnt lgkmcnt(8)
    v_mfma_f32_32x32x16_bf16 v[64:79], v[96:99], v[152:155], v[64:79]
    ds_read_b64_tr_b16 v[116:117], v5 offset:53248
    ds_read_b64_tr_b16 v[118:119], v5 offset:54272
    s_waitcnt lgkmcnt(8)
    v_mfma_f32_32x32x16_bf16 v[16:31], v[100:103], v[156:159], v[16:31]
    ds_read_b64_tr_b16 v[120:121], v2 offset:57344
    ds_read_b64_tr_b16 v[122:123], v2 offset:58368
    s_waitcnt lgkmcnt(8)
    v_mfma_f32_16x16x32_bf16 v[80:83], v[84:87], v[104:107], v[80:83]
    ds_read_b64_tr_b16 v[124:125], v6 offset:57344
    ds_read_b64_tr_b16 v[126:127], v6 offset:58368
    s_waitcnt lgkmcnt(8)
    v_mfma_f32_32x32x16_bf16 v[32:47], v[108:111], v[156:159], v[32:47]
    ds_read_b64_tr_b16 v[96:97], v3 offset:57344
    ds_read_b64_tr_b16 v[98:99], v3 offset:58368
    s_waitcnt lgkmcnt(8)
    v_mfma_f32_32x32x16_bf16 v[48:63], v[112:115], v[156:159], v[48:63]
    ds_read_b64_tr_b16 v[100:101], v4 offset:57344
    ds_read_b64_tr_b16 v[102:103], v4 offset:58368
    s_waitcnt lgkmcnt(8)
    v_mfma_f32_32x32x16_bf16 v[64:79], v[116:119], v[156:159], v[64:79]
    ds_read_b64_tr_b16 v[104:105], v5 offset:57344
    ds_read_b64_tr_b16 v[106:107], v5 offset:58368
    s_waitcnt lgkmcnt(8)
    v_mfma_f32_32x32x16_bf16 v[16:31], v[120:123], v[160:163], v[16:31]
    ds_read_b64_tr_b16 v[108:109], v2 offset:61440
    ds_read_b64_tr_b16 v[110:111], v2 offset:62464
    s_waitcnt lgkmcnt(8)
    v_mfma_f32_16x16x32_bf16 v[80:83], v[84:87], v[124:127], v[80:83]
    ds_read_b64_tr_b16 v[112:113], v6 offset:61440
    ds_read_b64_tr_b16 v[114:115], v6 offset:62464
    s_waitcnt lgkmcnt(8)
    v_mfma_f32_32x32x16_bf16 v[32:47], v[96:99], v[160:163], v[32:47]
    ds_read_b64_tr_b16 v[116:117], v3 offset:61440
    ds_read_b64_tr_b16 v[118:119], v3 offset:62464
    s_waitcnt lgkmcnt(8)
    v_mfma_f32_32x32x16_bf16 v[48:63], v[100:103], v[160:163], v[48:63]
    ds_read_b64_tr_b16 v[120:121], v4 offset:61440
    ds_read_b64_tr_b16 v[122:123], v4 offset:62464
    s_waitcnt lgkmcnt(8)
    v_mfma_f32_32x32x16_bf16 v[64:79], v[104:107], v[160:163], v[64:79]
    ds_read_b64_tr_b16 v[124:125], v5 offset:61440
    ds_read_b64_tr_b16 v[126:127], v5 offset:62464
    s_waitcnt lgkmcnt(8)
    v_mfma_f32_32x32x16_bf16 v[16:31], v[108:111], v[164:167], v[16:31]
    s_barrier
    ds_read_b128 v[136:139], v88 offset:16384
    ds_read_b128 v[140:143], v89 offset:16384
    ds_read_b128 v[144:147], v90 offset:16384
    ds_read_b128 v[148:151], v91 offset:16384
    v_add_u32 v2, 0x10000, v2
    v_add_u32 v3, 0x10000, v3
    v_add_u32 v4, 0x10000, v4
    v_add_u32 v5, 0x10000, v5
    v_add_u32 v6, 0x10000, v6
    ds_read_b64_tr_b16 v[96:97], v2 offset:0
    ds_read_b64_tr_b16 v[98:99], v2 offset:1024
    s_waitcnt lgkmcnt(8)
    v_mfma_f32_16x16x32_bf16 v[80:83], v[84:87], v[112:115], v[80:83]
    ds_read_b64_tr_b16 v[100:101], v6 offset:0
    ds_read_b64_tr_b16 v[102:103], v6 offset:1024
    s_waitcnt lgkmcnt(8)
    v_mfma_f32_32x32x16_bf16 v[32:47], v[116:119], v[164:167], v[32:47]
    ds_read_b64_tr_b16 v[104:105], v3 offset:0
    ds_read_b64_tr_b16 v[106:107], v3 offset:1024
    s_waitcnt lgkmcnt(8)
    v_mfma_f32_32x32x16_bf16 v[48:63], v[120:123], v[164:167], v[48:63]
    ds_read_b64_tr_b16 v[108:109], v4 offset:0
    ds_read_b64_tr_b16 v[110:111], v4 offset:1024
    s_waitcnt lgkmcnt(8)
    v_mfma_f32_32x32x16_bf16 v[64:79], v[124:127], v[164:167], v[64:79]
    ds_read_b64_tr_b16 v[112:113], v5 offset:0
    ds_read_b64_tr_b16 v[114:115], v5 offset:1024
    s_waitcnt lgkmcnt(8)
    v_mfma_f32_32x32x16_bf16 v[16:31], v[96:99], v[136:139], v[16:31]
    ds_read_b64_tr_b16 v[116:117], v2 offset:4096
    ds_read_b64_tr_b16 v[118:119], v2 offset:5120
    v_dot2_f32_bf16 v12, v136, v136, v12
    v_dot2_f32_bf16 v13, v137, v137, v13
    v_dot2_f32_bf16 v12, v138, v138, v12
    v_dot2_f32_bf16 v13, v139, v139, v13
    v_dot2_f32_bf16 v12, v140, v140, v12
    v_dot2_f32_bf16 v13, v141, v141, v13
    v_dot2_f32_bf16 v12, v142, v142, v12
    v_dot2_f32_bf16 v13, v143, v143, v13
    v_dot2_f32_bf16 v12, v144, v144, v12
    v_dot2_f32_bf16 v13, v145, v145, v13
    v_dot2_f32_bf16 v12, v146, v146, v12
    v_dot2_f32_bf16 v13, v147, v147, v13
    v_dot2_f32_bf16 v12, v148, v148, v12
    v_dot2_f32_bf16 v13, v149, v149, v13
    v_dot2_f32_bf16 v12, v150, v150, v12
    v_dot2_f32_bf16 v13, v151, v151, v13
    s_waitcnt lgkmcnt(8)
    v_mfma_f32_16x16x32_bf16 v[80:83], v[84:87], v[100:103], v[80:83]
    ds_read_b64_tr_b16 v[120:121], v6 offset:4096
    ds_read_b64_tr_b16 v[122:123], v6 offset:5120
    s_waitcnt lgkmcnt(8)
    v_mfma_f32_32x32x16_bf16 v[32:47], v[104:107], v[136:139], v[32:47]
    ds_read_b64_tr_b16 v[124:125], v3 offset:4096
    ds_read_b64_tr_b16 v[126:127], v3 offset:5120
    s_waitcnt lgkmcnt(8)
    v_mfma_f32_32x32x16_bf16 v[48:63], v[108:111], v[136:139], v[48:63]
    ds_read_b64_tr_b16 v[96:97], v4 offset:4096
    ds_read_b64_tr_b16 v[98:99], v4 offset:5120
    s_waitcnt lgkmcnt(8)
    v_mfma_f32_32x32x16_bf16 v[64:79], v[112:115], v[136:139], v[64:79]
    ds_read_b64_tr_b16 v[100:101], v5 offset:4096
    ds_read_b64_tr_b16 v[102:103], v5 offset:5120
    s_waitcnt lgkmcnt(8)
    v_mfma_f32_32x32x16_bf16 v[16:31], v[116:119], v[140:143], v[16:31]
    ds_read_b64_tr_b16 v[104:105], v2 offset:8192
    ds_read_b64_tr_b16 v[106:107], v2 offset:9216
    s_waitcnt lgkmcnt(8)
    v_mfma_f32_16x16x32_bf16 v[80:83], v[84:87], v[120:123], v[80:83]
    ds_read_b64_tr_b16 v[108:109], v6 offset:8192
    ds_read_b64_tr_b16 v[110:111], v6 offset:9216
    s_waitcnt lgkmcnt(8)
    v_mfma_f32_32x32x16_bf16 v[32:47], v[124:127], v[140:143], v[32:47]
    ds_read_b64_tr_b16 v[112:113], v3 offset:8192
    ds_read_b64_tr_b16 v[114:115], v3 offset:9216
    s_waitcnt lgkmcnt(8)
    v_mfma_f32_32x32x16_bf16 v[48:63], v[96:99], v[140:143], v[48:63]
    ds_read_b64_tr_b16 v[116:117], v4 offset:8192
    ds_read_b64_tr_b16 v[118:119], v4 offset:9216
    s_waitcnt lgkmcnt(8)
    v_mfma_f32_32x32x16_bf16 v[64:79], v[100:103], v[140:143], v[64:79]
    ds_read_b64_tr_b16 v[120:121], v5 offset:8192
    ds_read_b64_tr_b16 v[122:123], v5 offset:9216
    s_waitcnt lgkmcnt(8)
    v_mfma_f32_32x32x16_bf16 v[16:31], v[104:107], v[144:147], v[16:31]
    ds_read_b64_tr_b16 v[124:125], v2 offset:12288
    ds_read_b64_tr_b16 v[126:127], v2 offset:13312
    s_waitcnt lgkmcnt(8)
    v_mfma_f32_16x16x32_bf16 v[80:83], v[84:87], v[108:111], v[80:83]
    ds_read_b64_tr_b16 v[96:97], v6 offset:12288
    ds_read_b64_tr_b16 v[98:99], v6 offset:13312
    s_waitcnt lgkmcnt(8)
    v_mfma_f32_32x32x16_bf16 v[32:47], v[112:115], v[144:147], v[32:47]
    ds_read_b64_tr_b16 v[100:101], v3 offset:12288
    ds_read_b64_tr_b16 v[102:103], v3 offset:13312
    s_waitcnt lgkmcnt(8)
    v_mfma_f32_32x32x16_bf16 v[48:63], v[116:119], v[144:147], v[48:63]
    ds_read_b64_tr_b16 v[104:105], v4 offset:12288
    ds_read_b64_tr_b16 v[106:107], v4 offset:13312
    s_waitcnt lgkmcnt(8)
    v_mfma_f32_32x32x16_bf16 v[64:79], v[120:123], v[144:147], v[64:79]
    ds_read_b64_tr_b16 v[108:109], v5 offset:12288
    ds_read_b64_tr_b16 v[110:111], v5 offset:13312
    s_waitcnt lgkmcnt(8)
    v_mfma_f32_32x32x16_bf16 v[16:31], v[124:127], v[148:151], v[16:31]
    s_barrier
    ds_read_b128 v[152:155], v88 offset:32768
    ds_read_b128 v[156:159], v89 offset:32768
    ds_read_b128 v[160:163], v90 offset:32768
    ds_read_b128 v[164:167], v91 offset:32768
    ds_read_b64_tr_b16 v[112:113], v2 offset:16384
    ds_read_b64_tr_b16 v[114:115], v2 offset:17408
    s_waitcnt lgkmcnt(8)
    v_mfma_f32_16x16x32_bf16 v[80:83], v[84:87], v[96:99], v[80:83]
    ds_read_b64_tr_b16 v[116:117], v6 offset:16384
    ds_read_b64_tr_b16 v[118:119], v6 offset:17408
    s_waitcnt lgkmcnt(8)
    v_mfma_f32_32x32x16_bf16 v[32:47], v[100:103], v[148:151], v[32:47]
    ds_read_b64_tr_b16 v[120:121], v3 offset:16384
    ds_read_b64_tr_b16 v[122:123], v3 offset:17408
    s_waitcnt lgkmcnt(8)
    v_mfma_f32_32x32x16_bf16 v[48:63], v[104:107], v[148:151], v[48:63]
    ds_read_b64_tr_b16 v[124:125], v4 offset:16384
    ds_read_b64_tr_b16 v[126:127], v4 offset:17408
    s_waitcnt lgkmcnt(8)
    v_mfma_f32_32x32x16_bf16 v[64:79], v[108:111], v[148:151], v[64:79]
    ds_read_b64_tr_b16 v[96:97], v5 offset:16384
    ds_read_b64_tr_b16 v[98:99], v5 offset:17408
    s_waitcnt lgkmcnt(8)
    v_mfma_f32_32x32x16_bf16 v[16:31], v[112:115], v[152:155], v[16:31]
    ds_read_b64_tr_b16 v[100:101], v2 offset:20480
    ds_read_b64_tr_b16 v[102:103], v2 offset:21504
    v_dot2_f32_bf16 v12, v152, v152, v12
    v_dot2_f32_bf16 v13, v153, v153, v13
    v_dot2_f32_bf16 v12, v154, v154, v12
    v_dot2_f32_bf16 v13, v155, v155, v13
    v_dot2_f32_bf16 v12, v156, v156, v12
    v_dot2_f32_bf16 v13, v157, v157, v13
    v_dot2_f32_bf16 v12, v158, v158, v12
    v_dot2_f32_bf16 v13, v159, v159, v13
    v_dot2_f32_bf16 v12, v160, v160, v12
    v_dot2_f32_bf16 v13, v161, v161, v13
    v_dot2_f32_bf16 v12, v162, v162, v12
    v_dot2_f32_bf16 v13, v163, v163, v13
    v_dot2_f32_bf16 v12, v164, v164, v12
    v_dot2_f32_bf16 v13, v165, v165, v13
    v_dot2_f32_bf16 v12, v166, v166, v12
    v_dot2_f32_bf16 v13, v167, v167, v13
    s_waitcnt lgkmcnt(8)
    v_mfma_f32_16x16x32_bf16 v[80:83], v[84:87], v[116:119], v[80:83]
    ds_read_b64_tr_b16 v[104:105], v6 offset:20480
    ds_read_b64_tr_b16 v[106:107], v6 offset:21504
    s_waitcnt lgkmcnt(8)
    v_mfma_f32_32x32x16_bf16 v[32:47], v[120:123], v[152:155], v[32:47]
    ds_read_b64_tr_b16 v[108:109], v3 offset:20480
    ds_read_b64_tr_b16 v[110:111], v3 offset:21504
    s_waitcnt lgkmcnt(8)
    v_mfma_f32_32x32x16_bf16 v[48:63], v[124:127], v[152:155], v[48:63]
    ds_read_b64_tr_b16 v[112:113], v4 offset:20480
    ds_read_b64_tr_b16 v[114:115], v4 offset:21504
    s_waitcnt lgkmcnt(8)
    v_mfma_f32_32x32x16_bf16 v[64:79], v[96:99], v[152:155], v[64:79]
    ds_read_b64_tr_b16 v[116:117], v5 offset:20480
    ds_read_b64_tr_b16 v[118:119], v5 offset:21504
    s_waitcnt lgkmcnt(8)
    v_mfma_f32_32x32x16_bf16 v[16:31], v[100:103], v[156:159], v[16:31]
    ds_read_b64_tr_b16 v[120:121], v2 offset:24576
    ds_read_b64_tr_b16 v[122:123], v2 offset:25600
    s_waitcnt lgkmcnt(8)
    v_mfma_f32_16x16x32_bf16 v[80:83], v[84:87], v[104:107], v[80:83]
    ds_read_b64_tr_b16 v[124:125], v6 offset:24576
    ds_read_b64_tr_b16 v[126:127], v6 offset:25600
    s_waitcnt lgkmcnt(8)
    v_mfma_f32_32x32x16_bf16 v[32:47], v[108:111], v[156:159], v[32:47]
    ds_read_b64_tr_b16 v[96:97], v3 offset:24576
    ds_read_b64_tr_b16 v[98:99], v3 offset:25600
    s_waitcnt lgkmcnt(8)
    v_mfma_f32_32x32x16_bf16 v[48:63], v[112:115], v[156:159], v[48:63]
    ds_read_b64_tr_b16 v[100:101], v4 offset:24576
    ds_read_b64_tr_b16 v[102:103], v4 offset:25600
    s_waitcnt lgkmcnt(8)
    v_mfma_f32_32x32x16_bf16 v[64:79], v[116:119], v[156:159], v[64:79]
    ds_read_b64_tr_b16 v[104:105], v5 offset:24576
    ds_read_b64_tr_b16 v[106:107], v5 offset:25600
    s_waitcnt lgkmcnt(8)
    v_mfma_f32_32x32x16_bf16 v[16:31], v[120:123], v[160:163], v[16:31]
    ds_read_b64_tr_b16 v[108:109], v2 offset:28672
    ds_read_b64_tr_b16 v[110:111], v2 offset:29696
    s_waitcnt lgkmcnt(8)
    v_mfma_f32_16x16x32_bf16 v[80:83], v[84:87], v[124:127], v[80:83]
    ds_read_b64_tr_b16 v[112:113], v6 offset:28672
    ds_read_b64_tr_b16 v[114:115], v6 offset:29696
    s_waitcnt lgkmcnt(8)
    v_mfma_f32_32x32x16_bf16 v[32:47], v[96:99], v[160:163], v[32:47]
    ds_read_b64_tr_b16 v[116:117], v3 offset:28672
    ds_read_b64_tr_b16 v[118:119], v3 offset:29696
    s_waitcnt lgkmcnt(8)
    v_mfma_f32_32x32x16_bf16 v[48:63], v[100:103], v[160:163], v[48:63]
    ds_read_b64_tr_b16 v[120:121], v4 offset:28672
    ds_read_b64_tr_b16 v[122:123], v4 offset:29696
    s_waitcnt lgkmcnt(8)
    v_mfma_f32_32x32x16_bf16 v[64:79], v[104:107], v[160:163], v[64:79]
    ds_read_b64_tr_b16 v[124:125], v5 offset:28672
    ds_read_b64_tr_b16 v[126:127], v5 offset:29696
    s_waitcnt lgkmcnt(8)
    v_mfma_f32_32x32x16_bf16 v[16:31], v[108:111], v[164:167], v[16:31]
    s_barrier
    ds_read_b128 v[136:139], v88 offset:0
    ds_read_b128 v[140:143], v89 offset:0
    ds_read_b128 v[144:147], v90 offset:0
    ds_read_b128 v[148:151], v91 offset:0
    ds_read_b64_tr_b16 v[96:97], v2 offset:32768
    ds_read_b64_tr_b16 v[98:99], v2 offset:33792
    s_waitcnt lgkmcnt(8)
    v_mfma_f32_16x16x32_bf16 v[80:83], v[84:87], v[112:115], v[80:83]
    ds_read_b64_tr_b16 v[100:101], v6 offset:32768
    ds_read_b64_tr_b16 v[102:103], v6 offset:33792
    s_waitcnt lgkmcnt(8)
    v_mfma_f32_32x32x16_bf16 v[32:47], v[116:119], v[164:167], v[32:47]
    ds_read_b64_tr_b16 v[104:105], v3 offset:32768
    ds_read_b64_tr_b16 v[106:107], v3 offset:33792
    s_waitcnt lgkmcnt(8)
    v_mfma_f32_32x32x16_bf16 v[48:63], v[120:123], v[164:167], v[48:63]
    ds_read_b64_tr_b16 v[108:109], v4 offset:32768
    ds_read_b64_tr_b16 v[110:111], v4 offset:33792
    s_waitcnt lgkmcnt(8)
    v_mfma_f32_32x32x16_bf16 v[64:79], v[124:127], v[164:167], v[64:79]
    ds_read_b64_tr_b16 v[112:113], v5 offset:32768
    ds_read_b64_tr_b16 v[114:115], v5 offset:33792
    s_waitcnt lgkmcnt(8)
    v_mfma_f32_32x32x16_bf16 v[16:31], v[96:99], v[136:139], v[16:31]
    ds_read_b64_tr_b16 v[116:117], v2 offset:36864
    ds_read_b64_tr_b16 v[118:119], v2 offset:37888
    v_dot2_f32_bf16 v12, v136, v136, v12
    v_dot2_f32_bf16 v13, v137, v137, v13
    v_dot2_f32_bf16 v12, v138, v138, v12
    v_dot2_f32_bf16 v13, v139, v139, v13
    v_dot2_f32_bf16 v12, v140, v140, v12
    v_dot2_f32_bf16 v13, v141, v141, v13
    v_dot2_f32_bf16 v12, v142, v142, v12
    v_dot2_f32_bf16 v13, v143, v143, v13
    v_dot2_f32_bf16 v12, v144, v144, v12
    v_dot2_f32_bf16 v13, v145, v145, v13
    v_dot2_f32_bf16 v12, v146, v146, v12
    v_dot2_f32_bf16 v13, v147, v147, v13
    v_dot2_f32_bf16 v12, v148, v148, v12
    v_dot2_f32_bf16 v13, v149, v149, v13
    v_dot2_f32_bf16 v12, v150, v150, v12
    v_dot2_f32_bf16 v13, v151, v151, v13
    s_waitcnt lgkmcnt(8)
    v_mfma_f32_16x16x32_bf16 v[80:83], v[84:87], v[100:103], v[80:83]
    ds_read_b64_tr_b16 v[120:121], v6 offset:36864
    ds_read_b64_tr_b16 v[122:123], v6 offset:37888
    s_waitcnt lgkmcnt(8)
    v_mfma_f32_32x32x16_bf16 v[32:47], v[104:107], v[136:139], v[32:47]
    ds_read_b64_tr_b16 v[124:125], v3 offset:36864
    ds_read_b64_tr_b16 v[126:127], v3 offset:37888
    s_waitcnt lgkmcnt(8)
    v_mfma_f32_32x32x16_bf16 v[48:63], v[108:111], v[136:139], v[48:63]
    ds_read_b64_tr_b16 v[96:97], v4 offset:36864
    ds_read_b64_tr_b16 v[98:99], v4 offset:37888
    s_waitcnt lgkmcnt(8)
    v_mfma_f32_32x32x16_bf16 v[64:79], v[112:115], v[136:139], v[64:79]
    ds_read_b64_tr_b16 v[100:101], v5 offset:36864
    ds_read_b64_tr_b16 v[102:103], v5 offset:37888
    s_waitcnt lgkmcnt(8)
    v_mfma_f32_32x32x16_bf16 v[16:31], v[116:119], v[140:143], v[16:31]
    ds_read_b64_tr_b16 v[104:105], v2 offset:40960
    ds_read_b64_tr_b16 v[106:107], v2 offset:41984
    s_waitcnt lgkmcnt(8)
    v_mfma_f32_16x16x32_bf16 v[80:83], v[84:87], v[120:123], v[80:83]
    ds_read_b64_tr_b16 v[108:109], v6 offset:40960
    ds_read_b64_tr_b16 v[110:111], v6 offset:41984
    s_waitcnt lgkmcnt(8)
    v_mfma_f32_32x32x16_bf16 v[32:47], v[124:127], v[140:143], v[32:47]
    ds_read_b64_tr_b16 v[112:113], v3 offset:40960
    ds_read_b64_tr_b16 v[114:115], v3 offset:41984
    s_waitcnt lgkmcnt(8)
    v_mfma_f32_32x32x16_bf16 v[48:63], v[96:99], v[140:143], v[48:63]
    ds_read_b64_tr_b16 v[116:117], v4 offset:40960
    ds_read_b64_tr_b16 v[118:119], v4 offset:41984
    s_waitcnt lgkmcnt(8)
    v_mfma_f32_32x32x16_bf16 v[64:79], v[100:103], v[140:143], v[64:79]
    ds_read_b64_tr_b16 v[120:121], v5 offset:40960
    ds_read_b64_tr_b16 v[122:123], v5 offset:41984
    s_waitcnt lgkmcnt(8)
    v_mfma_f32_32x32x16_bf16 v[16:31], v[104:107], v[144:147], v[16:31]
    ds_read_b64_tr_b16 v[124:125], v5 offset:45056
    ds_read_b64_tr_b16 v[126:127], v5 offset:46080
    s_waitcnt lgkmcnt(8)
    v_mfma_f32_16x16x32_bf16 v[80:83], v[84:87], v[108:111], v[80:83]
    ds_read_b64_tr_b16 v[96:97], v6 offset:45056
    ds_read_b64_tr_b16 v[98:99], v6 offset:46080
    s_waitcnt lgkmcnt(8)
    v_mfma_f32_32x32x16_bf16 v[32:47], v[112:115], v[144:147], v[32:47]
    ds_read_b64_tr_b16 v[100:101], v2 offset:45056
    ds_read_b64_tr_b16 v[102:103], v2 offset:46080
    s_waitcnt lgkmcnt(8)
    v_mfma_f32_32x32x16_bf16 v[48:63], v[116:119], v[144:147], v[48:63]
    ds_read_b64_tr_b16 v[104:105], v3 offset:45056
    ds_read_b64_tr_b16 v[106:107], v3 offset:46080
    s_waitcnt lgkmcnt(8)
    v_mfma_f32_32x32x16_bf16 v[64:79], v[120:123], v[144:147], v[64:79]
    ds_read_b64_tr_b16 v[108:109], v4 offset:45056
    ds_read_b64_tr_b16 v[110:111], v4 offset:46080
    s_waitcnt lgkmcnt(8)
    v_mfma_f32_32x32x16_bf16 v[64:79], v[124:127], v[148:151], v[64:79]
    s_waitcnt lgkmcnt(6)
    v_mfma_f32_16x16x32_bf16 v[80:83], v[84:87], v[96:99], v[80:83]
    s_waitcnt lgkmcnt(4)
    v_mfma_f32_32x32x16_bf16 v[16:31], v[100:103], v[148:151], v[16:31]
    s_waitcnt lgkmcnt(2)
    v_mfma_f32_32x32x16_bf16 v[32:47], v[104:107], v[148:151], v[32:47]
    s_waitcnt lgkmcnt(0)
    v_mfma_f32_32x32x16_bf16 v[48:63], v[108:111], v[148:151], v[48:63]
    s_nop 1
    v_cvt_pk_bf16_f32 v96, v80, v80
    v_and_b32 v96, 0xffff0000, v96
    v_sub_f32 v96, v80, v96
    v_cvt_pk_bf16_f32 v96, v80, v96
    v_cvt_pk_bf16_f32 v97, v81, v81
    v_and_b32 v97, 0xffff0000, v97
    v_sub_f32 v97, v81, v97
    v_cvt_pk_bf16_f32 v97, v81, v97
    s_lshl_b32 s26, s46, 7
    v_add_u32 v11, s26, v10
    s_mov_b64 exec, 0xffff
    ds_write2_b32 v11, v96, v97 offset1:16
    s_mov_b64 exec, -1
    v_mov_b32 v14, v76
    v_mov_b32 v15, v76
    v_add_f32 v13, v12, v13
    s_nop 0
    v_permlane32_swap_b32 v15, v14
    v_mov_b32 v12, v13
    s_nop 1
    v_permlane32_swap_b32 v13, v12
    v_add_f32 v13, v13, v12
    v_mul_f32 v12, 0x3b124925, v14
    v_mul_f32 v13, 0x3b124925, v13
    v_fma_f32 v13, -v12, v12, v13
    v_max_f32 v13, 0, v13
    v_cvt_pk_bf16_f32 v15, v13, v13
    v_and_b32 v15, 0xffff0000, v15
    v_add_f32 v9, 0x3727c5ac, v13
    v_add_f32 v15, 0x3727c5ac, v15
    v_mov_b32 v14, 0x3727c5ac
    v_fma_f32 v9, v9, v14, v13
    v_cvt_pk_bf16_f32 v15, v15, v15
    v_and_b32 v15, 0xffff0000, v15
    v_sqrt_f32 v9, v9
    v_sqrt_f32 v15, v15
    s_waitcnt lgkmcnt(0)
    s_barrier
    ds_read_b32 v96, v10 offset:0
    ds_read_b32 v100, v10 offset:128
    ds_read_b32 v104, v10 offset:256
    ds_read_b32 v108, v10 offset:384
    v_cvt_pk_bf16_f32 v252, -v12, -v12
    v_and_b32 v8, 0xffff0000, v252
    v_sub_f32 v8, -v12, v8
    v_cvt_pk_bf16_f32 v253, v8, 0
    v_and_b32 v253, s55, v253
    v_lshrrev_b32 v8, 5, v1
    v_add_u32 v8, -1, v8
    v_and_b32 v252, v8, v252
    v_and_b32 v253, v8, v253
    v_mov_b32 v14, s55
    v_cvt_pk_bf16_f32 v15, v15, v15
    v_and_b32 v15, 0xffff0000, v15
    v_cvt_pk_bf16_f32 v10, v12, v12
    v_and_b32 v10, 0xffff0000, v10
    v_bfi_b32 v255, v14, v9, v15
    v_rcp_f32 v254, v255
    s_waitcnt lgkmcnt(0)
    v_mov_b32 v112, v252
    v_mov_b32 v113, v253
    v_mov_b32 v114, 0
    v_mov_b32 v115, 0
    v_and_b32 v97, 0xffff, v96
    v_mov_b32 v98, 0
    v_mov_b32 v99, 0
    v_and_b32 v101, 0xffff, v100
    v_mov_b32 v102, 0
    v_mov_b32 v103, 0
    v_and_b32 v105, 0xffff, v104
    v_mov_b32 v106, 0
    v_mov_b32 v107, 0
    v_and_b32 v109, 0xffff, v108
    v_mov_b32 v110, 0
    v_mov_b32 v111, 0
    v_mfma_f32_32x32x16_bf16 v[16:31], v[96:99], v[112:115], v[16:31]
    v_mfma_f32_32x32x16_bf16 v[32:47], v[100:103], v[112:115], v[32:47]
    v_mfma_f32_32x32x16_bf16 v[48:63], v[104:107], v[112:115], v[48:63]
    v_mfma_f32_32x32x16_bf16 v[64:79], v[108:111], v[112:115], v[64:79]
    s_lshl_b32 s3, s56, 8
    s_add_u32 s3, s3, 22020096
    s_cmp_eq_u32 s45, 0
    s_cselect_b32 s3, s3, 2147483648
    v_lshlrev_b32 v8, 3, v1
    v_and_b32 v8, 0xff, v8
    v_mov_b32 v11, v254
    buffer_store_dwordx2 v[10:11], v8, s[36:39], s3 offen sc1
    v_lshrrev_b32 v8, 5, v1
    v_add_u32 v8, -1, v8
    s_cmp_eq_u32 s47, 3
    s_cbranch_scc1 P1_h
    s_cmp_eq_u32 s47, 0
    s_cselect_b32 s3, 0x3e8b97f6, 1.0
    v_mul_f32 v10, s3, v254
    v_mul_u32_u24 v12, 12, v1
    s_lshl_b32 s3, s48, 8
    s_add_u32 s3, s3, s56
    s_movk_i32 s27, 3584
    s_cmp_eq_u32 s47, 0
    s_cselect_b32 s27, 1792, s27
    s_mul_i32 s3, s3, s27
    s_lshl_b32 s26, s27, 6
    s_mov_b32 s27, 2097152
    s_cmp_eq_u32 s47, 0
    s_cselect_b32 s27, 0, s27
    s_add_u32 s3, s3, s27
    s_cmp_eq_u32 s47, 2
    s_cbranch_scc1 P1_v
    v_pk_mul_f32 v[16:17], v[16:17], v[10:11] op_sel_hi:[1,0]
    v_pk_mul_f32 v[18:19], v[18:19], v[10:11] op_sel_hi:[1,0]
    v_pk_mul_f32 v[20:21], v[20:21], v[10:11] op_sel_hi:[1,0]
    v_pk_mul_f32 v[22:23], v[22:23], v[10:11] op_sel_hi:[1,0]
    v_pk_mul_f32 v[24:25], v[24:25], v[10:11] op_sel_hi:[1,0]
    v_pk_mul_f32 v[26:27], v[26:27], v[10:11] op_sel_hi:[1,0]
    v_pk_mul_f32 v[28:29], v[28:29], v[10:11] op_sel_hi:[1,0]
    v_pk_mul_f32 v[30:31], v[30:31], v[10:11] op_sel_hi:[1,0]
    v_cvt_pk_bf16_f32 v136, v16, v17
    v_cvt_pk_bf16_f32 v137, v18, v19
    v_cvt_pk_bf16_f32 v138, v20, v21
    v_cvt_pk_bf16_f32 v139, v22, v23
    v_cvt_pk_bf16_f32 v140, v24, v25
    v_cvt_pk_bf16_f32 v141, v26, v27
    v_cvt_pk_bf16_f32 v142, v28, v29
    v_cvt_pk_bf16_f32 v143, v30, v31
    buffer_store_dwordx4 v[136:139], v0, s[36:39], s3 offen sc1
    s_nop 0
    v_permlane32_swap_b32 v142, v143
    buffer_store_dwordx3 v[140:142], v12, s[36:39], s3 offen offset:1024 sc1
    s_add_u32 s3, s3, s26
    v_pk_mul_f32 v[32:33], v[32:33], v[10:11] op_sel_hi:[1,0]
    v_pk_mul_f32 v[34:35], v[34:35], v[10:11] op_sel_hi:[1,0]
    v_pk_mul_f32 v[36:37], v[36:37], v[10:11] op_sel_hi:[1,0]
    v_pk_mul_f32 v[38:39], v[38:39], v[10:11] op_sel_hi:[1,0]
    v_pk_mul_f32 v[40:41], v[40:41], v[10:11] op_sel_hi:[1,0]
    v_pk_mul_f32 v[42:43], v[42:43], v[10:11] op_sel_hi:[1,0]
    v_pk_mul_f32 v[44:45], v[44:45], v[10:11] op_sel_hi:[1,0]
    v_pk_mul_f32 v[46:47], v[46:47], v[10:11] op_sel_hi:[1,0]
    v_cvt_pk_bf16_f32 v144, v32, v33
    v_cvt_pk_bf16_f32 v145, v34, v35
    v_cvt_pk_bf16_f32 v146, v36, v37
    v_cvt_pk_bf16_f32 v147, v38, v39
    v_cvt_pk_bf16_f32 v148, v40, v41
    v_cvt_pk_bf16_f32 v149, v42, v43
    v_cvt_pk_bf16_f32 v150, v44, v45
    v_cvt_pk_bf16_f32 v151, v46, v47
    buffer_store_dwordx4 v[144:147], v0, s[36:39], s3 offen sc1
    s_nop 0
    v_permlane32_swap_b32 v150, v151
    buffer_store_dwordx3 v[148:150], v12, s[36:39], s3 offen offset:1024 sc1
    s_add_u32 s3, s3, s26
    v_pk_mul_f32 v[48:49], v[48:49], v[10:11] op_sel_hi:[1,0]
    v_pk_mul_f32 v[50:51], v[50:51], v[10:11] op_sel_hi:[1,0]
    v_pk_mul_f32 v[52:53], v[52:53], v[10:11] op_sel_hi:[1,0]
    v_pk_mul_f32 v[54:55], v[54:55], v[10:11] op_sel_hi:[1,0]
    v_pk_mul_f32 v[56:57], v[56:57], v[10:11] op_sel_hi:[1,0]
    v_pk_mul_f32 v[58:59], v[58:59], v[10:11] op_sel_hi:[1,0]
    v_pk_mul_f32 v[60:61], v[60:61], v[10:11] op_sel_hi:[1,0]
    v_pk_mul_f32 v[62:63], v[62:63], v[10:11] op_sel_hi:[1,0]
    v_cvt_pk_bf16_f32 v152, v48, v49
    v_cvt_pk_bf16_f32 v153, v50, v51
    v_cvt_pk_bf16_f32 v154, v52, v53
    v_cvt_pk_bf16_f32 v155, v54, v55
    v_cvt_pk_bf16_f32 v156, v56, v57
    v_cvt_pk_bf16_f32 v157, v58, v59
    v_cvt_pk_bf16_f32 v158, v60, v61
    v_cvt_pk_bf16_f32 v159, v62, v63
    buffer_store_dwordx4 v[152:155], v0, s[36:39], s3 offen sc1
    s_nop 0
    v_permlane32_swap_b32 v158, v159
    buffer_store_dwordx3 v[156:158], v12, s[36:39], s3 offen offset:1024 sc1
    s_add_u32 s3, s3, s26
    v_pk_mul_f32 v[64:65], v[64:65], v[10:11] op_sel_hi:[1,0]
    v_pk_mul_f32 v[66:67], v[66:67], v[10:11] op_sel_hi:[1,0]
    v_pk_mul_f32 v[68:69], v[68:69], v[10:11] op_sel_hi:[1,0]
    v_pk_mul_f32 v[70:71], v[70:71], v[10:11] op_sel_hi:[1,0]
    v_pk_mul_f32 v[72:73], v[72:73], v[10:11] op_sel_hi:[1,0]
    v_pk_mul_f32 v[74:75], v[74:75], v[10:11] op_sel_hi:[1,0]
    v_pk_mul_f32 v[76:77], v[76:77], v[10:11] op_sel_hi:[1,0]
    v_pk_mul_f32 v[78:79], v[78:79], v[10:11] op_sel_hi:[1,0]
    v_cvt_pk_bf16_f32 v160, v64, v65
    v_cvt_pk_bf16_f32 v161, v66, v67
    v_cvt_pk_bf16_f32 v162, v68, v69
    v_cvt_pk_bf16_f32 v163, v70, v71
    v_cvt_pk_bf16_f32 v164, v72, v73
    v_cvt_pk_bf16_f32 v165, v74, v75
    v_cvt_pk_bf16_f32 v166, v76, v77
    v_cvt_pk_bf16_f32 v167, v78, v79
    buffer_store_dwordx4 v[160:163], v0, s[36:39], s3 offen sc1
    s_nop 0
    v_permlane32_swap_b32 v166, v167
    buffer_store_dwordx3 v[164:166], v12, s[36:39], s3 offen offset:1024 sc1
    s_branch P1_done
P1_v:
    s_mul_i32 s27, s46, 9216
    s_add_u32 s27, s27, 0x10000
    v_and_b32 v9, 31, v1
    v_mul_u32_u24 v9, 72, v9
    v_lshrrev_b32 v14, 5, v1
    v_lshl_add_u32 v9, v14, 3, v9
    v_add_u32 v9, s27, v9
    v_bfe_u32 v15, v1, 2, 2
    v_lshl_add_u32 v14, v14, 2, v15
    v_mul_u32_u24 v14, 72, v14
    v_bfe_u32 v15, v1, 4, 1
    v_lshl_add_u32 v14, v15, 5, v14
    v_and_b32 v15, 3, v1
    v_lshl_add_u32 v14, v15, 3, v14
    v_add_u32 v14, s27, v14
    v_lshrrev_b32 v15, 5, v1
    v_lshlrev_b32 v15, 6, v15
    v_sub_u32 v13, v0, v15
    v_and_b32 v15, 31, v1
    v_cmp_gt_u32 vcc, 28, v15
    v_mov_b32 v15, 2147483648
    s_nop 0
    v_cndmask_b32 v13, v15, v13, vcc
    v_pk_mul_f32 v[16:17], v[16:17], v[10:11] op_sel_hi:[1,0]
    v_pk_mul_f32 v[18:19], v[18:19], v[10:11] op_sel_hi:[1,0]
    v_pk_mul_f32 v[20:21], v[20:21], v[10:11] op_sel_hi:[1,0]
    v_pk_mul_f32 v[22:23], v[22:23], v[10:11] op_sel_hi:[1,0]
    v_pk_mul_f32 v[24:25], v[24:25], v[10:11] op_sel_hi:[1,0]
    v_pk_mul_f32 v[26:27], v[26:27], v[10:11] op_sel_hi:[1,0]
    v_pk_mul_f32 v[28:29], v[28:29], v[10:11] op_sel_hi:[1,0]
    v_pk_mul_f32 v[30:31], v[30:31], v[10:11] op_sel_hi:[1,0]
    v_cvt_pk_bf16_f32 v136, v16, v17
    v_cvt_pk_bf16_f32 v137, v18, v19
    v_cvt_pk_bf16_f32 v138, v20, v21
    v_cvt_pk_bf16_f32 v139, v22, v23
    v_cvt_pk_bf16_f32 v140, v24, v25
    v_cvt_pk_bf16_f32 v141, v26, v27
    v_cvt_pk_bf16_f32 v142, v28, v29
    v_cvt_pk_bf16_f32 v143, v30, v31
    ds_write_b64 v9, v[136:137] offset:0
    ds_write_b64 v9, v[138:139] offset:16
    ds_write_b64 v9, v[140:141] offset:32
    ds_write_b64 v9, v[142:143] offset:48
    s_waitcnt lgkmcnt(0)
    ds_read_b64_tr_b16 v[136:137], v14 offset:0
    ds_read_b64_tr_b16 v[138:139], v14 offset:576
    ds_read_b64_tr_b16 v[140:141], v14 offset:1152
    ds_read_b64_tr_b16 v[142:143], v14 offset:1728
    v_pk_mul_f32 v[32:33], v[32:33], v[10:11] op_sel_hi:[1,0]
    v_pk_mul_f32 v[34:35], v[34:35], v[10:11] op_sel_hi:[1,0]
    v_pk_mul_f32 v[36:37], v[36:37], v[10:11] op_sel_hi:[1,0]
    v_pk_mul_f32 v[38:39], v[38:39], v[10:11] op_sel_hi:[1,0]
    v_pk_mul_f32 v[40:41], v[40:41], v[10:11] op_sel_hi:[1,0]
    v_pk_mul_f32 v[42:43], v[42:43], v[10:11] op_sel_hi:[1,0]
    v_pk_mul_f32 v[44:45], v[44:45], v[10:11] op_sel_hi:[1,0]
    v_pk_mul_f32 v[46:47], v[46:47], v[10:11] op_sel_hi:[1,0]
    v_cvt_pk_bf16_f32 v144, v32, v33
    v_cvt_pk_bf16_f32 v145, v34, v35
    v_cvt_pk_bf16_f32 v146, v36, v37
    v_cvt_pk_bf16_f32 v147, v38, v39
    v_cvt_pk_bf16_f32 v148, v40, v41
    v_cvt_pk_bf16_f32 v149, v42, v43
    v_cvt_pk_bf16_f32 v150, v44, v45
    v_cvt_pk_bf16_f32 v151, v46, v47
    ds_write_b64 v9, v[144:145] offset:2304
    ds_write_b64 v9, v[146:147] offset:2320
    ds_write_b64 v9, v[148:149] offset:2336
    ds_write_b64 v9, v[150:151] offset:2352
    s_waitcnt lgkmcnt(4)
    buffer_store_dwordx4 v[136:139], v13, s[36:39], s3 offen offset:1792 sc1
    buffer_store_dwordx4 v[140:143], v13, s[36:39], s3 offen offset:2688 sc1
    s_add_u32 s3, s3, s26
    s_waitcnt lgkmcnt(0)
    ds_read_b64_tr_b16 v[144:145], v14 offset:2304
    ds_read_b64_tr_b16 v[146:147], v14 offset:2880
    ds_read_b64_tr_b16 v[148:149], v14 offset:3456
    ds_read_b64_tr_b16 v[150:151], v14 offset:4032
    v_pk_mul_f32 v[48:49], v[48:49], v[10:11] op_sel_hi:[1,0]
    v_pk_mul_f32 v[50:51], v[50:51], v[10:11] op_sel_hi:[1,0]
    v_pk_mul_f32 v[52:53], v[52:53], v[10:11] op_sel_hi:[1,0]
    v_pk_mul_f32 v[54:55], v[54:55], v[10:11] op_sel_hi:[1,0]
    v_pk_mul_f32 v[56:57], v[56:57], v[10:11] op_sel_hi:[1,0]
    v_pk_mul_f32 v[58:59], v[58:59], v[10:11] op_sel_hi:[1,0]
    v_pk_mul_f32 v[60:61], v[60:61], v[10:11] op_sel_hi:[1,0]
    v_pk_mul_f32 v[62:63], v[62:63], v[10:11] op_sel_hi:[1,0]
    v_cvt_pk_bf16_f32 v152, v48, v49
    v_cvt_pk_bf16_f32 v153, v50, v51
    v_cvt_pk_bf16_f32 v154, v52, v53
    v_cvt_pk_bf16_f32 v155, v54, v55
    v_cvt_pk_bf16_f32 v156, v56, v57
    v_cvt_pk_bf16_f32 v157, v58, v59
    v_cvt_pk_bf16_f32 v158, v60, v61
    v_cvt_pk_bf16_f32 v159, v62, v63
    ds_write_b64 v9, v[152:153] offset:4608
    ds_write_b64 v9, v[154:155] offset:4624
    ds_write_b64 v9, v[156:157] offset:4640
    ds_write_b64 v9, v[158:159] offset:4656
    s_waitcnt lgkmcnt(4)
    buffer_store_dwordx4 v[144:147], v13, s[36:39], s3 offen offset:1792 sc1
    buffer_store_dwordx4 v[148:151], v13, s[36:39], s3 offen offset:2688 sc1
    s_add_u32 s3, s3, s26
    s_waitcnt lgkmcnt(0)
    ds_read_b64_tr_b16 v[152:153], v14 offset:4608
    ds_read_b64_tr_b16 v[154:155], v14 offset:5184
    ds_read_b64_tr_b16 v[156:157], v14 offset:5760
    ds_read_b64_tr_b16 v[158:159], v14 offset:6336
    v_pk_mul_f32 v[64:65], v[64:65], v[10:11] op_sel_hi:[1,0]
    v_pk_mul_f32 v[66:67], v[66:67], v[10:11] op_sel_hi:[1,0]
    v_pk_mul_f32 v[68:69], v[68:69], v[10:11] op_sel_hi:[1,0]
    v_pk_mul_f32 v[70:71], v[70:71], v[10:11] op_sel_hi:[1,0]
    v_pk_mul_f32 v[72:73], v[72:73], v[10:11] op_sel_hi:[1,0]
    v_pk_mul_f32 v[74:75], v[74:75], v[10:11] op_sel_hi:[1,0]
    v_pk_mul_f32 v[76:77], v[76:77], v[10:11] op_sel_hi:[1,0]
    v_pk_mul_f32 v[78:79], v[78:79], v[10:11] op_sel_hi:[1,0]
    v_cvt_pk_bf16_f32 v160, v64, v65
    v_cvt_pk_bf16_f32 v161, v66, v67
    v_cvt_pk_bf16_f32 v162, v68, v69
    v_cvt_pk_bf16_f32 v163, v70, v71
    v_cvt_pk_bf16_f32 v164, v72, v73
    v_cvt_pk_bf16_f32 v165, v74, v75
    v_cvt_pk_bf16_f32 v166, v76, v77
    v_cvt_pk_bf16_f32 v167, v78, v79
    ds_write_b64 v9, v[160:161] offset:6912
    ds_write_b64 v9, v[162:163] offset:6928
    ds_write_b64 v9, v[164:165] offset:6944
    ds_write_b64 v9, v[166:167] offset:6960
    s_waitcnt lgkmcnt(4)
    buffer_store_dwordx4 v[152:155], v13, s[36:39], s3 offen offset:1792 sc1
    buffer_store_dwordx4 v[156:159], v13, s[36:39], s3 offen offset:2688 sc1
    s_add_u32 s3, s3, s26
    s_waitcnt lgkmcnt(0)
    ds_read_b64_tr_b16 v[160:161], v14 offset:6912
    ds_read_b64_tr_b16 v[162:163], v14 offset:7488
    ds_read_b64_tr_b16 v[164:165], v14 offset:8064
    ds_read_b64_tr_b16 v[166:167], v14 offset:8640
    s_waitcnt lgkmcnt(0)
    buffer_store_dwordx4 v[160:163], v13, s[36:39], s3 offen offset:1792 sc1
    buffer_store_dwordx4 v[164:167], v13, s[36:39], s3 offen offset:2688 sc1
    s_branch P1_done
P1_h:
    v_mul_f32 v10, 0xc0135761, v254
    v_mul_f32 v12, v254, v254
    v_mul_f32 v12, v12, v254
    v_mul_f32 v12, 0xbdd2d3e8, v12
    v_mov_b32 v14, v255
    s_mul_i32 s3, s56, 28
    s_mul_i32 s27, s48, 7
    s_add_u32 s3, s3, s27
    s_lshl_b32 s3, s3, 10
    s_add_u32 s3, s3, 6291456
    s_add_u32 s27, s3, 4096
    v_pk_mul_f32 v[96:97], v[16:17], v[16:17]
    v_pk_mul_f32 v[98:99], v[18:19], v[18:19]
    v_pk_mul_f32 v[100:101], v[20:21], v[20:21]
    v_pk_mul_f32 v[102:103], v[22:23], v[22:23]
    v_pk_fma_f32 v[96:97], v[96:97], v[12:13], v[10:11] op_sel_hi:[1,0,0]
    v_pk_fma_f32 v[98:99], v[98:99], v[12:13], v[10:11] op_sel_hi:[1,0,0]
    v_pk_fma_f32 v[100:101], v[100:101], v[12:13], v[10:11] op_sel_hi:[1,0,0]
    v_pk_fma_f32 v[102:103], v[102:103], v[12:13], v[10:11] op_sel_hi:[1,0,0]
    v_pk_mul_f32 v[96:97], v[96:97], v[16:17]
    v_pk_mul_f32 v[98:99], v[98:99], v[18:19]
    v_pk_mul_f32 v[100:101], v[100:101], v[20:21]
    v_pk_mul_f32 v[102:103], v[102:103], v[22:23]
    v_exp_f32 v96, v96
    v_exp_f32 v97, v97
    v_exp_f32 v98, v98
    v_exp_f32 v99, v99
    v_exp_f32 v100, v100
    v_exp_f32 v101, v101
    v_exp_f32 v102, v102
    v_exp_f32 v103, v103
    v_pk_fma_f32 v[96:97], v[96:97], v[14:15], v[14:15] op_sel_hi:[1,0,0]
    v_pk_fma_f32 v[98:99], v[98:99], v[14:15], v[14:15] op_sel_hi:[1,0,0]
    v_pk_fma_f32 v[100:101], v[100:101], v[14:15], v[14:15] op_sel_hi:[1,0,0]
    v_pk_fma_f32 v[102:103], v[102:103], v[14:15], v[14:15] op_sel_hi:[1,0,0]
    v_rcp_f32 v96, v96
    v_rcp_f32 v97, v97
    v_rcp_f32 v98, v98
    v_rcp_f32 v99, v99
    v_rcp_f32 v100, v100
    v_rcp_f32 v101, v101
    v_rcp_f32 v102, v102
    v_rcp_f32 v103, v103
    v_pk_mul_f32 v[16:17], v[96:97], v[16:17]
    v_pk_mul_f32 v[18:19], v[98:99], v[18:19]
    v_pk_mul_f32 v[20:21], v[100:101], v[20:21]
    v_pk_mul_f32 v[22:23], v[102:103], v[22:23]
    v_cvt_pk_bf16_f32 v136, v16, v17
    v_cvt_pk_bf16_f32 v137, v18, v19
    v_cvt_pk_bf16_f32 v138, v20, v21
    v_cvt_pk_bf16_f32 v139, v22, v23
    buffer_store_dwordx4 v[136:139], v0, s[36:39], s3 offen offset:0 sc1
    v_pk_mul_f32 v[96:97], v[24:25], v[24:25]
    v_pk_mul_f32 v[98:99], v[26:27], v[26:27]
    v_pk_mul_f32 v[100:101], v[28:29], v[28:29]
    v_pk_mul_f32 v[102:103], v[30:31], v[30:31]
    v_pk_fma_f32 v[96:97], v[96:97], v[12:13], v[10:11] op_sel_hi:[1,0,0]
    v_pk_fma_f32 v[98:99], v[98:99], v[12:13], v[10:11] op_sel_hi:[1,0,0]
    v_pk_fma_f32 v[100:101], v[100:101], v[12:13], v[10:11] op_sel_hi:[1,0,0]
    v_pk_fma_f32 v[102:103], v[102:103], v[12:13], v[10:11] op_sel_hi:[1,0,0]
    v_pk_mul_f32 v[96:97], v[96:97], v[24:25]
    v_pk_mul_f32 v[98:99], v[98:99], v[26:27]
    v_pk_mul_f32 v[100:101], v[100:101], v[28:29]
    v_pk_mul_f32 v[102:103], v[102:103], v[30:31]
    v_exp_f32 v96, v96
    v_exp_f32 v97, v97
    v_exp_f32 v98, v98
    v_exp_f32 v99, v99
    v_exp_f32 v100, v100
    v_exp_f32 v101, v101
    v_exp_f32 v102, v102
    v_exp_f32 v103, v103
    v_pk_fma_f32 v[96:97], v[96:97], v[14:15], v[14:15] op_sel_hi:[1,0,0]
    v_pk_fma_f32 v[98:99], v[98:99], v[14:15], v[14:15] op_sel_hi:[1,0,0]
    v_pk_fma_f32 v[100:101], v[100:101], v[14:15], v[14:15] op_sel_hi:[1,0,0]
    v_pk_fma_f32 v[102:103], v[102:103], v[14:15], v[14:15] op_sel_hi:[1,0,0]
    v_rcp_f32 v96, v96
    v_rcp_f32 v97, v97
    v_rcp_f32 v98, v98
    v_rcp_f32 v99, v99
    v_rcp_f32 v100, v100
    v_rcp_f32 v101, v101
    v_rcp_f32 v102, v102
    v_rcp_f32 v103, v103
    v_pk_mul_f32 v[24:25], v[96:97], v[24:25]
    v_pk_mul_f32 v[26:27], v[98:99], v[26:27]
    v_pk_mul_f32 v[28:29], v[100:101], v[28:29]
    v_pk_mul_f32 v[30:31], v[102:103], v[30:31]
    v_cvt_pk_bf16_f32 v140, v24, v25
    v_cvt_pk_bf16_f32 v141, v26, v27
    v_cvt_pk_bf16_f32 v142, v28, v29
    v_cvt_pk_bf16_f32 v143, v30, v31
    buffer_store_dwordx4 v[140:143], v0, s[36:39], s3 offen offset:1024 sc1
    v_pk_mul_f32 v[96:97], v[32:33], v[32:33]
    v_pk_mul_f32 v[98:99], v[34:35], v[34:35]
    v_pk_mul_f32 v[100:101], v[36:37], v[36:37]
    v_pk_mul_f32 v[102:103], v[38:39], v[38:39]
    v_pk_fma_f32 v[96:97], v[96:97], v[12:13], v[10:11] op_sel_hi:[1,0,0]
    v_pk_fma_f32 v[98:99], v[98:99], v[12:13], v[10:11] op_sel_hi:[1,0,0]
    v_pk_fma_f32 v[100:101], v[100:101], v[12:13], v[10:11] op_sel_hi:[1,0,0]
    v_pk_fma_f32 v[102:103], v[102:103], v[12:13], v[10:11] op_sel_hi:[1,0,0]
    v_pk_mul_f32 v[96:97], v[96:97], v[32:33]
    v_pk_mul_f32 v[98:99], v[98:99], v[34:35]
    v_pk_mul_f32 v[100:101], v[100:101], v[36:37]
    v_pk_mul_f32 v[102:103], v[102:103], v[38:39]
    v_exp_f32 v96, v96
    v_exp_f32 v97, v97
    v_exp_f32 v98, v98
    v_exp_f32 v99, v99
    v_exp_f32 v100, v100
    v_exp_f32 v101, v101
    v_exp_f32 v102, v102
    v_exp_f32 v103, v103
    v_pk_fma_f32 v[96:97], v[96:97], v[14:15], v[14:15] op_sel_hi:[1,0,0]
    v_pk_fma_f32 v[98:99], v[98:99], v[14:15], v[14:15] op_sel_hi:[1,0,0]
    v_pk_fma_f32 v[100:101], v[100:101], v[14:15], v[14:15] op_sel_hi:[1,0,0]
    v_pk_fma_f32 v[102:103], v[102:103], v[14:15], v[14:15] op_sel_hi:[1,0,0]
    v_rcp_f32 v96, v96
    v_rcp_f32 v97, v97
    v_rcp_f32 v98, v98
    v_rcp_f32 v99, v99
    v_rcp_f32 v100, v100
    v_rcp_f32 v101, v101
    v_rcp_f32 v102, v102
    v_rcp_f32 v103, v103
    v_pk_mul_f32 v[32:33], v[96:97], v[32:33]
    v_pk_mul_f32 v[34:35], v[98:99], v[34:35]
    v_pk_mul_f32 v[36:37], v[100:101], v[36:37]
    v_pk_mul_f32 v[38:39], v[102:103], v[38:39]
    v_cvt_pk_bf16_f32 v144, v32, v33
    v_cvt_pk_bf16_f32 v145, v34, v35
    v_cvt_pk_bf16_f32 v146, v36, v37
    v_cvt_pk_bf16_f32 v147, v38, v39
    buffer_store_dwordx4 v[144:147], v0, s[36:39], s3 offen offset:2048 sc1
    v_pk_mul_f32 v[96:97], v[40:41], v[40:41]
    v_pk_mul_f32 v[98:99], v[42:43], v[42:43]
    v_pk_mul_f32 v[100:101], v[44:45], v[44:45]
    v_pk_mul_f32 v[102:103], v[46:47], v[46:47]
    v_pk_fma_f32 v[96:97], v[96:97], v[12:13], v[10:11] op_sel_hi:[1,0,0]
    v_pk_fma_f32 v[98:99], v[98:99], v[12:13], v[10:11] op_sel_hi:[1,0,0]
    v_pk_fma_f32 v[100:101], v[100:101], v[12:13], v[10:11] op_sel_hi:[1,0,0]
    v_pk_fma_f32 v[102:103], v[102:103], v[12:13], v[10:11] op_sel_hi:[1,0,0]
    v_pk_mul_f32 v[96:97], v[96:97], v[40:41]
    v_pk_mul_f32 v[98:99], v[98:99], v[42:43]
    v_pk_mul_f32 v[100:101], v[100:101], v[44:45]
    v_pk_mul_f32 v[102:103], v[102:103], v[46:47]
    v_exp_f32 v96, v96
    v_exp_f32 v97, v97
    v_exp_f32 v98, v98
    v_exp_f32 v99, v99
    v_exp_f32 v100, v100
    v_exp_f32 v101, v101
    v_exp_f32 v102, v102
    v_exp_f32 v103, v103
    v_pk_fma_f32 v[96:97], v[96:97], v[14:15], v[14:15] op_sel_hi:[1,0,0]
    v_pk_fma_f32 v[98:99], v[98:99], v[14:15], v[14:15] op_sel_hi:[1,0,0]
    v_pk_fma_f32 v[100:101], v[100:101], v[14:15], v[14:15] op_sel_hi:[1,0,0]
    v_pk_fma_f32 v[102:103], v[102:103], v[14:15], v[14:15] op_sel_hi:[1,0,0]
    v_rcp_f32 v96, v96
    v_rcp_f32 v97, v97
    v_rcp_f32 v98, v98
    v_rcp_f32 v99, v99
    v_rcp_f32 v100, v100
    v_rcp_f32 v101, v101
    v_rcp_f32 v102, v102
    v_rcp_f32 v103, v103
    v_pk_mul_f32 v[40:41], v[96:97], v[40:41]
    v_pk_mul_f32 v[42:43], v[98:99], v[42:43]
    v_pk_mul_f32 v[44:45], v[100:101], v[44:45]
    v_pk_mul_f32 v[46:47], v[102:103], v[46:47]
    v_cvt_pk_bf16_f32 v148, v40, v41
    v_cvt_pk_bf16_f32 v149, v42, v43
    v_cvt_pk_bf16_f32 v150, v44, v45
    v_cvt_pk_bf16_f32 v151, v46, v47
    buffer_store_dwordx4 v[148:151], v0, s[36:39], s3 offen offset:3072 sc1
    v_pk_mul_f32 v[96:97], v[48:49], v[48:49]
    v_pk_mul_f32 v[98:99], v[50:51], v[50:51]
    v_pk_mul_f32 v[100:101], v[52:53], v[52:53]
    v_pk_mul_f32 v[102:103], v[54:55], v[54:55]
    v_pk_fma_f32 v[96:97], v[96:97], v[12:13], v[10:11] op_sel_hi:[1,0,0]
    v_pk_fma_f32 v[98:99], v[98:99], v[12:13], v[10:11] op_sel_hi:[1,0,0]
    v_pk_fma_f32 v[100:101], v[100:101], v[12:13], v[10:11] op_sel_hi:[1,0,0]
    v_pk_fma_f32 v[102:103], v[102:103], v[12:13], v[10:11] op_sel_hi:[1,0,0]
    v_pk_mul_f32 v[96:97], v[96:97], v[48:49]
    v_pk_mul_f32 v[98:99], v[98:99], v[50:51]
    v_pk_mul_f32 v[100:101], v[100:101], v[52:53]
    v_pk_mul_f32 v[102:103], v[102:103], v[54:55]
    v_exp_f32 v96, v96
    v_exp_f32 v97, v97
    v_exp_f32 v98, v98
    v_exp_f32 v99, v99
    v_exp_f32 v100, v100
    v_exp_f32 v101, v101
    v_exp_f32 v102, v102
    v_exp_f32 v103, v103
    v_pk_fma_f32 v[96:97], v[96:97], v[14:15], v[14:15] op_sel_hi:[1,0,0]
    v_pk_fma_f32 v[98:99], v[98:99], v[14:15], v[14:15] op_sel_hi:[1,0,0]
    v_pk_fma_f32 v[100:101], v[100:101], v[14:15], v[14:15] op_sel_hi:[1,0,0]
    v_pk_fma_f32 v[102:103], v[102:103], v[14:15], v[14:15] op_sel_hi:[1,0,0]
    v_rcp_f32 v96, v96
    v_rcp_f32 v97, v97
    v_rcp_f32 v98, v98
    v_rcp_f32 v99, v99
    v_rcp_f32 v100, v100
    v_rcp_f32 v101, v101
    v_rcp_f32 v102, v102
    v_rcp_f32 v103, v103
    v_pk_mul_f32 v[48:49], v[96:97], v[48:49]
    v_pk_mul_f32 v[50:51], v[98:99], v[50:51]
    v_pk_mul_f32 v[52:53], v[100:101], v[52:53]
    v_pk_mul_f32 v[54:55], v[102:103], v[54:55]
    v_cvt_pk_bf16_f32 v152, v48, v49
    v_cvt_pk_bf16_f32 v153, v50, v51
    v_cvt_pk_bf16_f32 v154, v52, v53
    v_cvt_pk_bf16_f32 v155, v54, v55
    buffer_store_dwordx4 v[152:155], v0, s[36:39], s27 offen offset:0 sc1
    v_pk_mul_f32 v[96:97], v[56:57], v[56:57]
    v_pk_mul_f32 v[98:99], v[58:59], v[58:59]
    v_pk_mul_f32 v[100:101], v[60:61], v[60:61]
    v_pk_mul_f32 v[102:103], v[62:63], v[62:63]
    v_pk_fma_f32 v[96:97], v[96:97], v[12:13], v[10:11] op_sel_hi:[1,0,0]
    v_pk_fma_f32 v[98:99], v[98:99], v[12:13], v[10:11] op_sel_hi:[1,0,0]
    v_pk_fma_f32 v[100:101], v[100:101], v[12:13], v[10:11] op_sel_hi:[1,0,0]
    v_pk_fma_f32 v[102:103], v[102:103], v[12:13], v[10:11] op_sel_hi:[1,0,0]
    v_pk_mul_f32 v[96:97], v[96:97], v[56:57]
    v_pk_mul_f32 v[98:99], v[98:99], v[58:59]
    v_pk_mul_f32 v[100:101], v[100:101], v[60:61]
    v_pk_mul_f32 v[102:103], v[102:103], v[62:63]
    v_exp_f32 v96, v96
    v_exp_f32 v97, v97
    v_exp_f32 v98, v98
    v_exp_f32 v99, v99
    v_exp_f32 v100, v100
    v_exp_f32 v101, v101
    v_exp_f32 v102, v102
    v_exp_f32 v103, v103
    v_pk_fma_f32 v[96:97], v[96:97], v[14:15], v[14:15] op_sel_hi:[1,0,0]
    v_pk_fma_f32 v[98:99], v[98:99], v[14:15], v[14:15] op_sel_hi:[1,0,0]
    v_pk_fma_f32 v[100:101], v[100:101], v[14:15], v[14:15] op_sel_hi:[1,0,0]
    v_pk_fma_f32 v[102:103], v[102:103], v[14:15], v[14:15] op_sel_hi:[1,0,0]
    v_rcp_f32 v96, v96
    v_rcp_f32 v97, v97
    v_rcp_f32 v98, v98
    v_rcp_f32 v99, v99
    v_rcp_f32 v100, v100
    v_rcp_f32 v101, v101
    v_rcp_f32 v102, v102
    v_rcp_f32 v103, v103
    v_pk_mul_f32 v[56:57], v[96:97], v[56:57]
    v_pk_mul_f32 v[58:59], v[98:99], v[58:59]
    v_pk_mul_f32 v[60:61], v[100:101], v[60:61]
    v_pk_mul_f32 v[62:63], v[102:103], v[62:63]
    v_cvt_pk_bf16_f32 v156, v56, v57
    v_cvt_pk_bf16_f32 v157, v58, v59
    v_cvt_pk_bf16_f32 v158, v60, v61
    v_cvt_pk_bf16_f32 v159, v62, v63
    buffer_store_dwordx4 v[156:159], v0, s[36:39], s27 offen offset:1024 sc1
    v_pk_mul_f32 v[96:97], v[64:65], v[64:65]
    v_pk_mul_f32 v[98:99], v[66:67], v[66:67]
    v_pk_mul_f32 v[100:101], v[68:69], v[68:69]
    v_pk_mul_f32 v[102:103], v[70:71], v[70:71]
    v_pk_fma_f32 v[96:97], v[96:97], v[12:13], v[10:11] op_sel_hi:[1,0,0]
    v_pk_fma_f32 v[98:99], v[98:99], v[12:13], v[10:11] op_sel_hi:[1,0,0]
    v_pk_fma_f32 v[100:101], v[100:101], v[12:13], v[10:11] op_sel_hi:[1,0,0]
    v_pk_fma_f32 v[102:103], v[102:103], v[12:13], v[10:11] op_sel_hi:[1,0,0]
    v_pk_mul_f32 v[96:97], v[96:97], v[64:65]
    v_pk_mul_f32 v[98:99], v[98:99], v[66:67]
    v_pk_mul_f32 v[100:101], v[100:101], v[68:69]
    v_pk_mul_f32 v[102:103], v[102:103], v[70:71]
    v_exp_f32 v96, v96
    v_exp_f32 v97, v97
    v_exp_f32 v98, v98
    v_exp_f32 v99, v99
    v_exp_f32 v100, v100
    v_exp_f32 v101, v101
    v_exp_f32 v102, v102
    v_exp_f32 v103, v103
    v_pk_fma_f32 v[96:97], v[96:97], v[14:15], v[14:15] op_sel_hi:[1,0,0]
    v_pk_fma_f32 v[98:99], v[98:99], v[14:15], v[14:15] op_sel_hi:[1,0,0]
    v_pk_fma_f32 v[100:101], v[100:101], v[14:15], v[14:15] op_sel_hi:[1,0,0]
    v_pk_fma_f32 v[102:103], v[102:103], v[14:15], v[14:15] op_sel_hi:[1,0,0]
    v_rcp_f32 v96, v96
    v_rcp_f32 v97, v97
    v_rcp_f32 v98, v98
    v_rcp_f32 v99, v99
    v_rcp_f32 v100, v100
    v_rcp_f32 v101, v101
    v_rcp_f32 v102, v102
    v_rcp_f32 v103, v103
    v_pk_mul_f32 v[64:65], v[96:97], v[64:65]
    v_pk_mul_f32 v[66:67], v[98:99], v[66:67]
    v_pk_mul_f32 v[68:69], v[100:101], v[68:69]
    v_pk_mul_f32 v[70:71], v[102:103], v[70:71]
    v_cvt_pk_bf16_f32 v160, v64, v65
    v_cvt_pk_bf16_f32 v161, v66, v67
    v_cvt_pk_bf16_f32 v162, v68, v69
    v_cvt_pk_bf16_f32 v163, v70, v71
    buffer_store_dwordx4 v[160:163], v0, s[36:39], s27 offen offset:2048 sc1
P1_done:
    s_mov_b64 exec, 1
    v_mov_b32 v8, 159772
    v_mov_b32 v9, 16
    ds_add_u32 v8, v9
    s_mov_b64 exec, -1
    s_waitcnt vmcnt(0)
    s_lshl_b32 s3, s45, 4
    s_add_u32 s3, s3, s44
    s_lshl_b32 s3, s3, 7
    s_add_u32 s3, s3, 22347776
    s_mov_b64 exec, 1
    v_mov_b32 v8, 159752
    v_mov_b32 v9, 1
    ds_add_rtn_u32 v8, v8, v9
    s_waitcnt lgkmcnt(0)
    v_readfirstlane_b32 s26, v8
    v_mov_b32 v8, 0
    s_nop 0
    s_cmp_eq_u32 s26, 7
    s_cselect_b32 s26, s3, 2147483648
    s_nop 0
    buffer_store_dword v9, v8, s[36:39], s26 offen sc1
    s_mov_b64 exec, -1
    s_and_b32 s26, s2, 7
    s_lshr_b32 s27, s2, 3
    s_lshl_b32 s44, s26, 1
    s_and_b32 s3, s27, 1
    s_add_u32 s44, s44, s3
    s_lshr_b32 s45, s27, 1
    s_mul_i32 s47, s46, 11136
    s_add_u32 s47, s47, 114688
    s_lshl_b32 s52, s44, 2
    s_add_u32 s52, s52, s46
    s_mul_i32 s52, s52, 57344
    s_add_u32 s52, s52, 2097152
    s_add_u32 s53, s52, 57344
    s_and_b32 s27, s45, 3
    s_mul_i32 s3, s27, 14336
    s_add_u32 s50, s52, s3
    s_mov_b32 s54, 0x0fffffff
    s_mov_b32 s55, 0x0fffffff
    v_mul_u32_u24 v4, 12, v1
    v_lshrrev_b32 v11, 5, v1
    v_lshlrev_b32 v12, 6, v11
    v_sub_u32 v224, v0, v12
    v_lshlrev_b32 v11, 4, v11
    v_mov_b32 v12, 0x3f803f80
    v_lshrrev_b32 v13, v11, v12
    v_and_b32 v11, 31, v1
    v_cmp_eq_u32 vcc, 28, v11
    s_nop 1
    v_cndmask_b32 v12, 0, v12, vcc
    s_lshr_b32 s3, s44, 2
    s_lshl_b32 s3, s3, 4
    v_and_b32 v10, 3, v1
    s_lshl_b32 s26, s46, 2
    s_add_u32 s26, s26, s3
    s_add_u32 s26, s26, 64
    v_add_u32 v10, s26, v10
    v_bfe_u32 v11, v1, 2, 1
    v_lshl_add_u32 v10, v11, 6, v10
    s_add_u32 s3, s3, s45
    v_writelane_b32 v10, s3, 8
    v_lshlrev_b32 v10, 7, v10
    v_add_u32 v10, 22347776, v10
    v_mov_b32 v16, 0
    v_mov_b32 v17, 0
    v_mov_b32 v18, 0
    v_mov_b32 v19, 0
    v_mov_b32 v20, 0
    v_mov_b32 v21, 0
    v_mov_b32 v22, 0
    v_mov_b32 v23, 0
    v_mov_b32 v24, 0
    v_mov_b32 v25, 0
    v_mov_b32 v26, 0
    v_mov_b32 v27, 0
    v_mov_b32 v28, 0
    v_mov_b32 v29, 0
    v_mov_b32 v30, 0
    v_mov_b32 v31, 0
    v_mov_b32 v32, 0
    v_mov_b32 v33, 0
    v_mov_b32 v34, 0
    v_mov_b32 v35, 0
    v_mov_b32 v36, 0
    v_mov_b32 v37, 0
    v_mov_b32 v38, 0
    v_mov_b32 v39, 0
    v_mov_b32 v40, 0
    v_mov_b32 v41, 0
    v_mov_b32 v42, 0
    v_mov_b32 v43, 0
    v_mov_b32 v44, 0
    v_mov_b32 v45, 0
    v_mov_b32 v46, 0
    v_mov_b32 v47, 0
    v_mov_b32 v48, 0
    v_mov_b32 v49, 0
    v_mov_b32 v50, 0
    v_mov_b32 v51, 0
    v_mov_b32 v52, 0
    v_mov_b32 v53, 0
    v_mov_b32 v54, 0
    v_mov_b32 v55, 0
    v_mov_b32 v56, 0
    v_mov_b32 v57, 0
    v_mov_b32 v58, 0
    v_mov_b32 v59, 0
    v_mov_b32 v60, 0
    v_mov_b32 v61, 0
    v_mov_b32 v62, 0
    v_mov_b32 v63, 0
    v_mov_b32 v64, 0
    v_mov_b32 v65, 0
    v_mov_b32 v66, 0
    v_mov_b32 v67, 0
    v_mov_b32 v68, 0
    v_mov_b32 v69, 0
    v_mov_b32 v70, 0
    v_mov_b32 v71, 0
    v_mov_b32 v72, 0
    v_mov_b32 v73, 0
    v_mov_b32 v74, 0
    v_mov_b32 v75, 0
    v_mov_b32 v76, 0
    v_mov_b32 v77, 0
    v_mov_b32 v78, 0
    v_mov_b32 v79, 0
    v_mov_b32 v144, 0
    v_mov_b32 v152, 0
    v_mov_b32 v145, 0
    v_mov_b32 v153, 0
    v_mov_b32 v146, 0
    v_mov_b32 v154, 0
    v_mov_b32 v147, 0
    v_mov_b32 v155, 0
    v_mov_b32 v148, 0
    v_mov_b32 v156, 0
    v_mov_b32 v149, 0
    v_mov_b32 v157, 0
    v_mov_b32 v150, 0
    v_mov_b32 v158, 0
    v_mov_b32 v151, 0
    v_mov_b32 v159, 0
    v_mov_b32 v167, v13
    v_mov_b32 v87, 0
    v_mov_b32 v168, v12
    v_mov_b32 v169, v12
    v_mov_b32 v170, v12
    v_mov_b32 v171, v12
    v_mov_b32 v172, v12
    v_mov_b32 v173, v12
    v_mov_b32 v174, v12
    v_mov_b32 v175, v12
    v_mov_b32 v183, v13
    v_mov_b32 v95, 0
    v_mov_b32 v184, v12
    v_mov_b32 v185, v12
    v_mov_b32 v186, v12
    v_mov_b32 v187, v12
    v_mov_b32 v188, v12
    v_mov_b32 v189, v12
    v_mov_b32 v190, v12
    v_mov_b32 v191, v12
    v_mov_b32 v199, v13
    v_mov_b32 v103, 0
    v_mov_b32 v200, v12
    v_mov_b32 v201, v12
    v_mov_b32 v202, v12
    v_mov_b32 v203, v12
    v_mov_b32 v204, v12
    v_mov_b32 v205, v12
    v_mov_b32 v206, v12
    v_mov_b32 v207, v12
    v_mov_b32 v215, v13
    v_mov_b32 v111, 0
    v_mov_b32 v216, v12
    v_mov_b32 v217, v12
    v_mov_b32 v218, v12
    v_mov_b32 v219, v12
    v_mov_b32 v220, v12
    v_mov_b32 v221, v12
    v_mov_b32 v222, v12
    v_mov_b32 v223, v12
    v_and_b32 v11, 7, v1
    v_lshlrev_b32 v11, 2, v11
    ds_bpermute_b32 v2, v11, v10
    s_lshl_b32 s27, s27, 2
    v_mov_b32 v11, s27
    v_writelane_b32 v11, 32, 2
    s_add_u32 s27, s27, 16
    v_writelane_b32 v11, s27, 1
    ds_bpermute_b32 v10, v11, v10
    s_waitcnt lgkmcnt(0)
    s_mov_b32 s58, 65536
    s_mov_b64 exec, 7
PL_7:
    buffer_load_dword v9, v10, s[36:39], 0 offen sc1
    s_waitcnt vmcnt(0)
    v_cmp_eq_u32 vcc, 0, v9
    s_nop 1
    s_cbranch_vccz PD_8
    s_sleep 6
    s_sub_u32 s58, s58, 1
    s_cmp_lg_u32 s58, 0
    s_cbranch_scc1 PL_7
PD_8:
    s_mov_b64 exec, -1
    s_mov_b32 s58, 524288
    v_mov_b32 v8, 159772
GL_9:
    ds_read_b32 v9, v8
    s_sub_u32 s58, s58, 1
    s_cbranch_scc1 GD_10
    s_waitcnt lgkmcnt(0)
    v_readfirstlane_b32 s3, v9
    s_nop 1
    s_bfe_u32 s3, s3, 262144
    s_cmp_lt_u32 s3, 4
    s_cbranch_scc1 GL_9
GD_10:
    s_waitcnt lgkmcnt(0)
    s_add_u32 s3, s46, 1
    s_and_b32 s3, s3, 3
    s_lshl_b32 s26, s44, 4
    s_add_u32 s26, s26, s45
    s_lshl_b32 s26, s26, 2
    s_add_u32 s3, s3, s26
    s_mul_i32 s3, s3, 1792
    s_add_u32 s3, s3, 0
    buffer_load_dwordx4 v[80:83], v0, s[36:39], s3 offen sc1
    buffer_load_dwordx3 v[84:86], v4, s[36:39], s3 offen offset:1024 sc1
    buffer_load_dwordx4 v[160:163], v0, s[36:39], s50 offen sc1
    buffer_load_dwordx3 v[164:166], v4, s[36:39], s50 offen offset:1024 sc1
    s_mov_b64 exec, s[54:55]
    buffer_load_dwordx4 v[168:171], v224, s[36:39], s50 offen offset:1792 sc1
    buffer_load_dwordx4 v[172:175], v224, s[36:39], s50 offen offset:2688 sc1
    s_mov_b64 exec, -1
    s_add_u32 s50, s50, 3584
    s_cmp_eq_u32 s50, s53
    s_cselect_b32 s50, s52, s50
    s_add_u32 s3, s46, 2
    s_and_b32 s3, s3, 3
    s_lshl_b32 s26, s44, 4
    s_add_u32 s26, s26, s45
    s_lshl_b32 s26, s26, 2
    s_add_u32 s3, s3, s26
    s_mul_i32 s3, s3, 1792
    s_add_u32 s3, s3, 0
    buffer_load_dwordx4 v[88:91], v0, s[36:39], s3 offen sc1
    buffer_load_dwordx3 v[92:94], v4, s[36:39], s3 offen offset:1024 sc1
    s_add_u32 s3, s46, 3
    s_and_b32 s3, s3, 3
    s_lshl_b32 s26, s44, 4
    s_add_u32 s26, s26, s45
    s_lshl_b32 s26, s26, 2
    s_add_u32 s3, s3, s26
    s_mul_i32 s3, s3, 1792
    s_add_u32 s3, s3, 0
    buffer_load_dwordx4 v[96:99], v0, s[36:39], s3 offen sc1
    buffer_load_dwordx3 v[100:102], v4, s[36:39], s3 offen offset:1024 sc1
    s_add_u32 s3, s46, 4
    s_and_b32 s3, s3, 3
    s_lshl_b32 s26, s44, 4
    s_add_u32 s26, s26, s45
    s_lshl_b32 s26, s26, 2
    s_add_u32 s3, s3, s26
    s_mul_i32 s3, s3, 1792
    s_add_u32 s3, s3, 0
    buffer_load_dwordx4 v[104:107], v0, s[36:39], s3 offen sc1
    buffer_load_dwordx3 v[108:110], v4, s[36:39], s3 offen offset:1024 sc1
    buffer_load_dwordx4 v[176:179], v0, s[36:39], s50 offen sc1
    buffer_load_dwordx3 v[180:182], v4, s[36:39], s50 offen offset:1024 sc1
    s_mov_b64 exec, s[54:55]
    buffer_load_dwordx4 v[184:187], v224, s[36:39], s50 offen offset:1792 sc1
    buffer_load_dwordx4 v[188:191], v224, s[36:39], s50 offen offset:2688 sc1
    s_mov_b64 exec, -1
    s_add_u32 s50, s50, 3584
    s_cmp_eq_u32 s50, s53
    s_cselect_b32 s50, s52, s50
    buffer_load_dwordx4 v[192:195], v0, s[36:39], s50 offen sc1
    buffer_load_dwordx3 v[196:198], v4, s[36:39], s50 offen offset:1024 sc1
    s_mov_b64 exec, s[54:55]
    buffer_load_dwordx4 v[200:203], v224, s[36:39], s50 offen offset:1792 sc1
    buffer_load_dwordx4 v[204:207], v224, s[36:39], s50 offen offset:2688 sc1
    s_mov_b64 exec, -1
    s_add_u32 s50, s50, 3584
    s_cmp_eq_u32 s50, s53
    s_cselect_b32 s50, s52, s50
    v_add_u32 v10, s47, v0
    v_lshlrev_b32 v14, 2, v1
    v_add_u32 v14, 3456, v14
    v_add_u32 v15, s47, v14
    v_mov_b32 v8, 159744
    s_lshl_b32 s26, s45, 2
    s_add_u32 s26, s26, s46
    s_lshl_b32 s26, s26, 4
    s_add_u32 s26, s26, s44
    s_lshl_b32 s62, s26, 11
    s_add_u32 s62, s62, 12582912
    s_lshl_b32 s63, s45, 4
    s_add_u32 s63, s63, s44
    s_lshl_b32 s63, s63, 7
    s_add_u32 s63, s63, 22446080
    s_sub_u32 s26, s46, 1
    s_and_b32 s26, s26, 3
    s_mul_i32 s26, s26, 11136
    s_add_u32 s26, s26, 114688
    v_add_u32 v11, s26, v0
    v_add_u32 v5, s26, v14
    s_sub_u32 s26, s46, 2
    s_and_b32 s26, s26, 3
    s_mul_i32 s26, s26, 11136
    s_add_u32 s26, s26, 114688
    v_add_u32 v12, s26, v0
    v_add_u32 v6, s26, v14
    s_sub_u32 s26, s46, 3
    s_and_b32 s26, s26, 3
    s_mul_i32 s26, s26, 11136
    s_add_u32 s26, s26, 114688
    v_add_u32 v13, s26, v0
    v_add_u32 v7, s26, v14
    s_mov_b32 s51, 4
    s_waitcnt vmcnt(14)
    v_mfma_f32_32x32x16_bf16 v[112:127], v[160:163], v[80:83], 0
    v_mfma_f32_32x32x16_bf16 v[112:127], v[164:167], v[84:87], v[112:127]
    s_setprio 0
    s_waitcnt vmcnt(8)
    s_nop 9
    .p2align 3
AT_loop:
    v_mfma_f32_32x32x16_bf16 v[128:143], v[160:163], v[88:91], 0
    v_exp_f32 v144, v112
    v_cvt_pk_bf16_f32 v158, v148, v149
    v_exp_f32 v145, v113
    v_cvt_pk_bf16_f32 v159, v150, v151
    v_exp_f32 v146, v114
    v_exp_f32 v147, v115
    v_mfma_f32_32x32x16_bf16 v[64:79], v[220:223], v[156:159], v[64:79]
    s_setprio 3
    buffer_load_dword v3, v2, s[36:39], 0 offen sc1
    buffer_load_dwordx4 v[208:211], v0, s[36:39], s50 offen sc1
    buffer_load_dwordx3 v[212:214], v4, s[36:39], s50 offen offset:1024 sc1
    v_exp_f32 v148, v116
    v_cvt_pk_bf16_f32 v152, v144, v145
    v_exp_f32 v149, v117
    v_cvt_pk_bf16_f32 v153, v146, v147
    v_exp_f32 v150, v118
    v_exp_f32 v151, v119
    v_mfma_f32_32x32x16_bf16 v[128:143], v[164:167], v[92:95], v[128:143]
    s_mov_b64 exec, s[54:55]
    buffer_load_dwordx4 v[216:219], v224, s[36:39], s50 offen offset:1792 sc1
    buffer_load_dwordx4 v[220:223], v224, s[36:39], s50 offen offset:2688 sc1
    s_mov_b64 exec, -1
    s_setprio 0
    v_exp_f32 v144, v120
    v_cvt_pk_bf16_f32 v154, v148, v149
    v_exp_f32 v145, v121
    v_cvt_pk_bf16_f32 v155, v150, v151
    v_exp_f32 v146, v122
    v_exp_f32 v147, v123
    v_mfma_f32_32x32x16_bf16 v[16:31], v[168:171], v[152:155], v[16:31]
    v_exp_f32 v148, v124
    v_cvt_pk_bf16_f32 v156, v144, v145
    v_exp_f32 v149, v125
    v_cvt_pk_bf16_f32 v157, v146, v147
    v_exp_f32 v150, v126
    v_exp_f32 v151, v127
    v_mfma_f32_32x32x16_bf16 v[112:127], v[160:163], v[96:99], 0
    v_exp_f32 v144, v128
    v_cvt_pk_bf16_f32 v158, v148, v149
    v_exp_f32 v145, v129
    v_cvt_pk_bf16_f32 v159, v150, v151
    v_exp_f32 v146, v130
    v_exp_f32 v147, v131
    v_mfma_f32_32x32x16_bf16 v[16:31], v[172:175], v[156:159], v[16:31]
    s_add_u32 s50, s50, 3584
    s_cmp_eq_u32 s50, s53
    s_cselect_b32 s50, s52, s50
    v_exp_f32 v148, v132
    v_cvt_pk_bf16_f32 v152, v144, v145
    v_exp_f32 v149, v133
    v_cvt_pk_bf16_f32 v153, v146, v147
    v_exp_f32 v150, v134
    v_exp_f32 v151, v135
    v_mfma_f32_32x32x16_bf16 v[112:127], v[164:167], v[100:103], v[112:127]
    s_cmp_eq_u32 s51, 1
    s_cselect_b32 s50, 2147483648, s50
    v_exp_f32 v144, v136
    v_cvt_pk_bf16_f32 v154, v148, v149
    v_exp_f32 v145, v137
    v_cvt_pk_bf16_f32 v155, v150, v151
    v_exp_f32 v146, v138
    v_exp_f32 v147, v139
    v_mfma_f32_32x32x16_bf16 v[32:47], v[168:171], v[152:155], v[32:47]
    v_exp_f32 v148, v140
    v_cvt_pk_bf16_f32 v156, v144, v145
    v_exp_f32 v149, v141
    v_cvt_pk_bf16_f32 v157, v146, v147
    v_exp_f32 v150, v142
    v_exp_f32 v151, v143
    v_mfma_f32_32x32x16_bf16 v[128:143], v[160:163], v[104:107], 0
    v_exp_f32 v144, v112
    v_cvt_pk_bf16_f32 v158, v148, v149
    v_exp_f32 v145, v113
    v_cvt_pk_bf16_f32 v159, v150, v151
    v_exp_f32 v146, v114
    v_exp_f32 v147, v115
    v_mfma_f32_32x32x16_bf16 v[32:47], v[172:175], v[156:159], v[32:47]
    v_exp_f32 v148, v116
    v_cvt_pk_bf16_f32 v152, v144, v145
    v_exp_f32 v149, v117
    v_cvt_pk_bf16_f32 v153, v146, v147
    v_exp_f32 v150, v118
    v_exp_f32 v151, v119
    v_mfma_f32_32x32x16_bf16 v[128:143], v[164:167], v[108:111], v[128:143]
    v_exp_f32 v144, v120
    v_cvt_pk_bf16_f32 v154, v148, v149
    v_exp_f32 v145, v121
    v_cvt_pk_bf16_f32 v155, v150, v151
    v_exp_f32 v146, v122
    v_exp_f32 v147, v123
    v_mfma_f32_32x32x16_bf16 v[48:63], v[168:171], v[152:155], v[48:63]
    v_exp_f32 v148, v124
    v_cvt_pk_bf16_f32 v156, v144, v145
    v_exp_f32 v149, v125
    v_cvt_pk_bf16_f32 v157, v146, v147
    v_exp_f32 v150, v126
    v_exp_f32 v151, v127
    s_waitcnt vmcnt(8)
    v_mfma_f32_32x32x16_bf16 v[112:127], v[176:179], v[80:83], 0
    v_exp_f32 v144, v128
    v_cvt_pk_bf16_f32 v158, v148, v149
    v_exp_f32 v145, v129
    v_cvt_pk_bf16_f32 v159, v150, v151
    v_exp_f32 v146, v130
    v_exp_f32 v147, v131
    v_mfma_f32_32x32x16_bf16 v[48:63], v[172:175], v[156:159], v[48:63]
    v_exp_f32 v148, v132
    v_cvt_pk_bf16_f32 v152, v144, v145
    v_exp_f32 v149, v133
    v_cvt_pk_bf16_f32 v153, v146, v147
    v_exp_f32 v150, v134
    v_exp_f32 v151, v135
    v_mfma_f32_32x32x16_bf16 v[112:127], v[180:183], v[84:87], v[112:127]
    v_exp_f32 v144, v136
    v_cvt_pk_bf16_f32 v154, v148, v149
    v_exp_f32 v145, v137
    v_cvt_pk_bf16_f32 v155, v150, v151
    v_exp_f32 v146, v138
    v_exp_f32 v147, v139
    v_mfma_f32_32x32x16_bf16 v[64:79], v[168:171], v[152:155], v[64:79]
    v_exp_f32 v148, v140
    v_cvt_pk_bf16_f32 v156, v144, v145
    v_exp_f32 v149, v141
    v_cvt_pk_bf16_f32 v157, v146, v147
    v_exp_f32 v150, v142
    v_exp_f32 v151, v143
    s_waitcnt vmcnt(4)
    v_cmp_eq_u32 vcc, 0, v3
    v_mfma_f32_32x32x16_bf16 v[128:143], v[176:179], v[88:91], 0
    v_exp_f32 v144, v112
    v_cvt_pk_bf16_f32 v158, v148, v149
    v_exp_f32 v145, v113
    v_cvt_pk_bf16_f32 v159, v150, v151
    v_exp_f32 v146, v114
    v_exp_f32 v147, v115
    v_mfma_f32_32x32x16_bf16 v[64:79], v[172:175], v[156:159], v[64:79]
    s_cbranch_vccnz AT_late
AT_ok:
    s_setprio 3
    buffer_load_dwordx4 v[160:163], v0, s[36:39], s50 offen sc1
    buffer_load_dwordx3 v[164:166], v4, s[36:39], s50 offen offset:1024 sc1
    v_exp_f32 v148, v116
    v_cvt_pk_bf16_f32 v152, v144, v145
    v_exp_f32 v149, v117
    v_cvt_pk_bf16_f32 v153, v146, v147
    v_exp_f32 v150, v118
    v_exp_f32 v151, v119
    v_mfma_f32_32x32x16_bf16 v[128:143], v[180:183], v[92:95], v[128:143]
    s_mov_b64 exec, s[54:55]
    buffer_load_dwordx4 v[168:171], v224, s[36:39], s50 offen offset:1792 sc1
    buffer_load_dwordx4 v[172:175], v224, s[36:39], s50 offen offset:2688 sc1
    s_mov_b64 exec, -1
    s_setprio 0
    v_exp_f32 v144, v120
    v_cvt_pk_bf16_f32 v154, v148, v149
    v_exp_f32 v145, v121
    v_cvt_pk_bf16_f32 v155, v150, v151
    v_exp_f32 v146, v122
    v_exp_f32 v147, v123
    v_mfma_f32_32x32x16_bf16 v[16:31], v[184:187], v[152:155], v[16:31]
    v_exp_f32 v148, v124
    v_cvt_pk_bf16_f32 v156, v144, v145
    v_exp_f32 v149, v125
    v_cvt_pk_bf16_f32 v157, v146, v147
    v_exp_f32 v150, v126
    v_exp_f32 v151, v127
    v_mfma_f32_32x32x16_bf16 v[112:127], v[176:179], v[96:99], 0
    v_exp_f32 v144, v128
    v_cvt_pk_bf16_f32 v158, v148, v149
    v_exp_f32 v145, v129
    v_cvt_pk_bf16_f32 v159, v150, v151
    v_exp_f32 v146, v130
    v_exp_f32 v147, v131
    v_mfma_f32_32x32x16_bf16 v[16:31], v[188:191], v[156:159], v[16:31]
    s_add_u32 s50, s50, 3584
    v_exp_f32 v148, v132
    v_cvt_pk_bf16_f32 v152, v144, v145
    v_exp_f32 v149, v133
    v_cvt_pk_bf16_f32 v153, v146, v147
    v_exp_f32 v150, v134
    v_exp_f32 v151, v135
    v_mfma_f32_32x32x16_bf16 v[112:127], v[180:183], v[100:103], v[112:127]
    v_exp_f32 v144, v136
    v_cvt_pk_bf16_f32 v154, v148, v149
    v_exp_f32 v145, v137
    v_cvt_pk_bf16_f32 v155, v150, v151
    v_exp_f32 v146, v138
    v_exp_f32 v147, v139
    v_mfma_f32_32x32x16_bf16 v[32:47], v[184:187], v[152:155], v[32:47]
    v_exp_f32 v148, v140
    v_cvt_pk_bf16_f32 v156, v144, v145
    v_exp_f32 v149, v141
    v_cvt_pk_bf16_f32 v157, v146, v147
    v_exp_f32 v150, v142
    v_exp_f32 v151, v143
    v_mfma_f32_32x32x16_bf16 v[128:143], v[176:179], v[104:107], 0
    v_exp_f32 v144, v112
    v_cvt_pk_bf16_f32 v158, v148, v149
    v_exp_f32 v145, v113
    v_cvt_pk_bf16_f32 v159, v150, v151
    v_exp_f32 v146, v114
    v_exp_f32 v147, v115
    v_mfma_f32_32x32x16_bf16 v[32:47], v[188:191], v[156:159], v[32:47]
    v_exp_f32 v148, v116
    v_cvt_pk_bf16_f32 v152, v144, v145
    v_exp_f32 v149, v117
    v_cvt_pk_bf16_f32 v153, v146, v147
    v_exp_f32 v150, v118
    v_exp_f32 v151, v119
    v_mfma_f32_32x32x16_bf16 v[128:143], v[180:183], v[108:111], v[128:143]
    v_exp_f32 v144, v120
    v_cvt_pk_bf16_f32 v154, v148, v149
    v_exp_f32 v145, v121
    v_cvt_pk_bf16_f32 v155, v150, v151
    v_exp_f32 v146, v122
    v_exp_f32 v147, v123
    v_mfma_f32_32x32x16_bf16 v[48:63], v[184:187], v[152:155], v[48:63]
    v_exp_f32 v148, v124
    v_cvt_pk_bf16_f32 v156, v144, v145
    v_exp_f32 v149, v125
    v_cvt_pk_bf16_f32 v157, v146, v147
    v_exp_f32 v150, v126
    v_exp_f32 v151, v127
    s_waitcnt vmcnt(8)
    v_mfma_f32_32x32x16_bf16 v[112:127], v[192:195], v[80:83], 0
    v_exp_f32 v144, v128
    v_cvt_pk_bf16_f32 v158, v148, v149
    v_exp_f32 v145, v129
    v_cvt_pk_bf16_f32 v159, v150, v151
    v_exp_f32 v146, v130
    v_exp_f32 v147, v131
    v_mfma_f32_32x32x16_bf16 v[48:63], v[188:191], v[156:159], v[48:63]
    v_exp_f32 v148, v132
    v_cvt_pk_bf16_f32 v152, v144, v145
    v_exp_f32 v149, v133
    v_cvt_pk_bf16_f32 v153, v146, v147
    v_exp_f32 v150, v134
    v_exp_f32 v151, v135
    v_mfma_f32_32x32x16_bf16 v[112:127], v[196:199], v[84:87], v[112:127]
    v_exp_f32 v144, v136
    v_cvt_pk_bf16_f32 v154, v148, v149
    v_exp_f32 v145, v137
    v_cvt_pk_bf16_f32 v155, v150, v151
    v_exp_f32 v146, v138
    v_exp_f32 v147, v139
    v_mfma_f32_32x32x16_bf16 v[64:79], v[184:187], v[152:155], v[64:79]
    v_exp_f32 v148, v140
    v_cvt_pk_bf16_f32 v156, v144, v145
    v_exp_f32 v149, v141
    v_cvt_pk_bf16_f32 v157, v146, v147
    v_exp_f32 v150, v142
    v_exp_f32 v151, v143
    v_mfma_f32_32x32x16_bf16 v[128:143], v[192:195], v[88:91], 0
    v_exp_f32 v144, v112
    v_cvt_pk_bf16_f32 v158, v148, v149
    v_exp_f32 v145, v113
    v_cvt_pk_bf16_f32 v159, v150, v151
    v_exp_f32 v146, v114
    v_exp_f32 v147, v115
    v_mfma_f32_32x32x16_bf16 v[64:79], v[188:191], v[156:159], v[64:79]
    s_setprio 3
    buffer_load_dwordx4 v[176:179], v0, s[36:39], s50 offen sc1
    buffer_load_dwordx3 v[180:182], v4, s[36:39], s50 offen offset:1024 sc1
    v_exp_f32 v148, v116
    v_cvt_pk_bf16_f32 v152, v144, v145
    v_exp_f32 v149, v117
    v_cvt_pk_bf16_f32 v153, v146, v147
    v_exp_f32 v150, v118
    v_exp_f32 v151, v119
    v_mfma_f32_32x32x16_bf16 v[128:143], v[196:199], v[92:95], v[128:143]
    s_mov_b64 exec, s[54:55]
    buffer_load_dwordx4 v[184:187], v224, s[36:39], s50 offen offset:1792 sc1
    buffer_load_dwordx4 v[188:191], v224, s[36:39], s50 offen offset:2688 sc1
    s_mov_b64 exec, -1
    s_setprio 0
    v_exp_f32 v144, v120
    v_cvt_pk_bf16_f32 v154, v148, v149
    v_exp_f32 v145, v121
    v_cvt_pk_bf16_f32 v155, v150, v151
    v_exp_f32 v146, v122
    v_exp_f32 v147, v123
    v_mfma_f32_32x32x16_bf16 v[16:31], v[200:203], v[152:155], v[16:31]
    v_exp_f32 v148, v124
    v_cvt_pk_bf16_f32 v156, v144, v145
    v_exp_f32 v149, v125
    v_cvt_pk_bf16_f32 v157, v146, v147
    v_exp_f32 v150, v126
    v_exp_f32 v151, v127
    v_mfma_f32_32x32x16_bf16 v[112:127], v[192:195], v[96:99], 0
    v_exp_f32 v144, v128
    v_cvt_pk_bf16_f32 v158, v148, v149
    v_exp_f32 v145, v129
    v_cvt_pk_bf16_f32 v159, v150, v151
    v_exp_f32 v146, v130
    v_exp_f32 v147, v131
    v_mfma_f32_32x32x16_bf16 v[16:31], v[204:207], v[156:159], v[16:31]
    s_add_u32 s50, s50, 3584
    v_exp_f32 v148, v132
    v_cvt_pk_bf16_f32 v152, v144, v145
    v_exp_f32 v149, v133
    v_cvt_pk_bf16_f32 v153, v146, v147
    v_exp_f32 v150, v134
    v_exp_f32 v151, v135
    v_mfma_f32_32x32x16_bf16 v[112:127], v[196:199], v[100:103], v[112:127]
    v_exp_f32 v144, v136
    v_cvt_pk_bf16_f32 v154, v148, v149
    v_exp_f32 v145, v137
    v_cvt_pk_bf16_f32 v155, v150, v151
    v_exp_f32 v146, v138
    v_exp_f32 v147, v139
    v_mfma_f32_32x32x16_bf16 v[32:47], v[200:203], v[152:155], v[32:47]
    v_exp_f32 v148, v140
    v_cvt_pk_bf16_f32 v156, v144, v145
    v_exp_f32 v149, v141
    v_cvt_pk_bf16_f32 v157, v146, v147
    v_exp_f32 v150, v142
    v_exp_f32 v151, v143
    v_mfma_f32_32x32x16_bf16 v[128:143], v[192:195], v[104:107], 0
    v_exp_f32 v144, v112
    v_cvt_pk_bf16_f32 v158, v148, v149
    v_exp_f32 v145, v113
    v_cvt_pk_bf16_f32 v159, v150, v151
    v_exp_f32 v146, v114
    v_exp_f32 v147, v115
    v_mfma_f32_32x32x16_bf16 v[32:47], v[204:207], v[156:159], v[32:47]
    v_exp_f32 v148, v116
    v_cvt_pk_bf16_f32 v152, v144, v145
    v_exp_f32 v149, v117
    v_cvt_pk_bf16_f32 v153, v146, v147
    v_exp_f32 v150, v118
    v_exp_f32 v151, v119
    v_mfma_f32_32x32x16_bf16 v[128:143], v[196:199], v[108:111], v[128:143]
    v_exp_f32 v144, v120
    v_cvt_pk_bf16_f32 v154, v148, v149
    v_exp_f32 v145, v121
    v_cvt_pk_bf16_f32 v155, v150, v151
    v_exp_f32 v146, v122
    v_exp_f32 v147, v123
    v_mfma_f32_32x32x16_bf16 v[48:63], v[200:203], v[152:155], v[48:63]
    v_exp_f32 v148, v124
    v_cvt_pk_bf16_f32 v156, v144, v145
    v_exp_f32 v149, v125
    v_cvt_pk_bf16_f32 v157, v146, v147
    v_exp_f32 v150, v126
    v_exp_f32 v151, v127
    s_waitcnt vmcnt(8)
    v_mfma_f32_32x32x16_bf16 v[112:127], v[208:211], v[80:83], 0
    v_exp_f32 v144, v128
    v_cvt_pk_bf16_f32 v158, v148, v149
    v_exp_f32 v145, v129
    v_cvt_pk_bf16_f32 v159, v150, v151
    v_exp_f32 v146, v130
    v_exp_f32 v147, v131
    v_mfma_f32_32x32x16_bf16 v[48:63], v[204:207], v[156:159], v[48:63]
    v_exp_f32 v148, v132
    v_cvt_pk_bf16_f32 v152, v144, v145
    v_exp_f32 v149, v133
    v_cvt_pk_bf16_f32 v153, v146, v147
    v_exp_f32 v150, v134
    v_exp_f32 v151, v135
    v_mfma_f32_32x32x16_bf16 v[112:127], v[212:215], v[84:87], v[112:127]
    v_exp_f32 v144, v136
    v_cvt_pk_bf16_f32 v154, v148, v149
    v_exp_f32 v145, v137
    v_cvt_pk_bf16_f32 v155, v150, v151
    v_exp_f32 v146, v138
    v_exp_f32 v147, v139
    v_mfma_f32_32x32x16_bf16 v[64:79], v[200:203], v[152:155], v[64:79]
    v_exp_f32 v148, v140
    v_cvt_pk_bf16_f32 v156, v144, v145
    v_exp_f32 v149, v141
    v_cvt_pk_bf16_f32 v157, v146, v147
    v_exp_f32 v150, v142
    v_exp_f32 v151, v143
    v_mfma_f32_32x32x16_bf16 v[128:143], v[208:211], v[88:91], 0
    v_exp_f32 v144, v112
    v_cvt_pk_bf16_f32 v158, v148, v149
    v_exp_f32 v145, v113
    v_cvt_pk_bf16_f32 v159, v150, v151
    v_exp_f32 v146, v114
    v_exp_f32 v147, v115
    v_mfma_f32_32x32x16_bf16 v[64:79], v[204:207], v[156:159], v[64:79]
    s_setprio 3
    buffer_load_dwordx4 v[192:195], v0, s[36:39], s50 offen sc1
    buffer_load_dwordx3 v[196:198], v4, s[36:39], s50 offen offset:1024 sc1
    v_exp_f32 v148, v116
    v_cvt_pk_bf16_f32 v152, v144, v145
    v_exp_f32 v149, v117
    v_cvt_pk_bf16_f32 v153, v146, v147
    v_exp_f32 v150, v118
    v_exp_f32 v151, v119
    v_mfma_f32_32x32x16_bf16 v[128:143], v[212:215], v[92:95], v[128:143]
    s_mov_b64 exec, s[54:55]
    buffer_load_dwordx4 v[200:203], v224, s[36:39], s50 offen offset:1792 sc1
    buffer_load_dwordx4 v[204:207], v224, s[36:39], s50 offen offset:2688 sc1
    s_mov_b64 exec, -1
    s_setprio 0
    v_exp_f32 v144, v120
    v_cvt_pk_bf16_f32 v154, v148, v149
    v_exp_f32 v145, v121
    v_cvt_pk_bf16_f32 v155, v150, v151
    v_exp_f32 v146, v122
    v_exp_f32 v147, v123
    v_mfma_f32_32x32x16_bf16 v[16:31], v[216:219], v[152:155], v[16:31]
    v_exp_f32 v148, v124
    v_cvt_pk_bf16_f32 v156, v144, v145
    v_exp_f32 v149, v125
    v_cvt_pk_bf16_f32 v157, v146, v147
    v_exp_f32 v150, v126
    v_exp_f32 v151, v127
    ds_read_b32 v9, v8
    v_mfma_f32_32x32x16_bf16 v[112:127], v[208:211], v[96:99], 0
    v_exp_f32 v144, v128
    v_cvt_pk_bf16_f32 v158, v148, v149
    v_exp_f32 v145, v129
    v_cvt_pk_bf16_f32 v159, v150, v151
    v_exp_f32 v146, v130
    v_exp_f32 v147, v131
    v_mfma_f32_32x32x16_bf16 v[16:31], v[220:223], v[156:159], v[16:31]
    s_add_u32 s50, s50, 3584
    v_exp_f32 v148, v132
    v_cvt_pk_bf16_f32 v152, v144, v145
    v_exp_f32 v149, v133
    v_cvt_pk_bf16_f32 v153, v146, v147
    v_exp_f32 v150, v134
    v_exp_f32 v151, v135
    v_mfma_f32_32x32x16_bf16 v[112:127], v[212:215], v[100:103], v[112:127]
    s_cmp_eq_u32 s51, 1
    v_exp_f32 v144, v136
    v_cvt_pk_bf16_f32 v154, v148, v149
    v_exp_f32 v145, v137
    v_cvt_pk_bf16_f32 v155, v150, v151
    v_exp_f32 v146, v138
    v_exp_f32 v147, v139
    v_mfma_f32_32x32x16_bf16 v[32:47], v[216:219], v[152:155], v[32:47]
    v_exp_f32 v148, v140
    v_cvt_pk_bf16_f32 v156, v144, v145
    v_exp_f32 v149, v141
    v_cvt_pk_bf16_f32 v157, v146, v147
    v_exp_f32 v150, v142
    v_exp_f32 v151, v143
    s_cbranch_scc1 AT_tail
    v_mfma_f32_32x32x16_bf16 v[128:143], v[208:211], v[104:107], 0
    v_exp_f32 v144, v112
    v_cvt_pk_bf16_f32 v158, v148, v149
    v_exp_f32 v145, v113
    v_cvt_pk_bf16_f32 v159, v150, v151
    v_exp_f32 v146, v114
    v_exp_f32 v147, v115
    v_mfma_f32_32x32x16_bf16 v[32:47], v[220:223], v[156:159], v[32:47]
    v_exp_f32 v148, v116
    v_cvt_pk_bf16_f32 v152, v144, v145
    v_exp_f32 v149, v117
    v_cvt_pk_bf16_f32 v153, v146, v147
    v_exp_f32 v150, v118
    v_exp_f32 v151, v119
    v_mfma_f32_32x32x16_bf16 v[128:143], v[212:215], v[108:111], v[128:143]
    v_exp_f32 v144, v120
    v_cvt_pk_bf16_f32 v154, v148, v149
    v_exp_f32 v145, v121
    v_cvt_pk_bf16_f32 v155, v150, v151
    v_exp_f32 v146, v122
    v_exp_f32 v147, v123
    v_mfma_f32_32x32x16_bf16 v[48:63], v[216:219], v[152:155], v[48:63]
    v_exp_f32 v148, v124
    v_cvt_pk_bf16_f32 v156, v144, v145
    v_exp_f32 v149, v125
    v_cvt_pk_bf16_f32 v157, v146, v147
    v_exp_f32 v150, v126
    v_exp_f32 v151, v127
    s_waitcnt vmcnt(8)
    v_mfma_f32_32x32x16_bf16 v[112:127], v[160:163], v[80:83], 0
    v_exp_f32 v144, v128
    v_cvt_pk_bf16_f32 v158, v148, v149
    v_exp_f32 v145, v129
    v_cvt_pk_bf16_f32 v159, v150, v151
    v_exp_f32 v146, v130
    v_exp_f32 v147, v131
    v_mfma_f32_32x32x16_bf16 v[48:63], v[220:223], v[156:159], v[48:63]
    v_exp_f32 v148, v132
    v_cvt_pk_bf16_f32 v152, v144, v145
    v_exp_f32 v149, v133
    v_cvt_pk_bf16_f32 v153, v146, v147
    v_exp_f32 v150, v134
    v_exp_f32 v151, v135
    v_mfma_f32_32x32x16_bf16 v[112:127], v[164:167], v[84:87], v[112:127]
    s_sub_u32 s51, s51, 1
    v_exp_f32 v144, v136
    v_cvt_pk_bf16_f32 v154, v148, v149
    v_exp_f32 v145, v137
    v_cvt_pk_bf16_f32 v155, v150, v151
    v_exp_f32 v146, v138
    v_exp_f32 v147, v139
    v_mfma_f32_32x32x16_bf16 v[64:79], v[216:219], v[152:155], v[64:79]
    v_exp_f32 v148, v140
    v_cvt_pk_bf16_f32 v156, v144, v145
    v_exp_f32 v149, v141
    v_cvt_pk_bf16_f32 v157, v146, v147
    v_exp_f32 v150, v142
    v_exp_f32 v151, v143
    s_branch AT_loop
AT_tail:
    s_setprio 2
    s_waitcnt lgkmcnt(0)
    v_readfirstlane_b32 s3, v9
    s_nop 1
    s_cmp_ge_u32 s3, 8
    s_cbranch_scc1 AT_free
    s_mov_b32 s58, 524288
    v_mov_b32 v8, 159744
GL_11:
    ds_read_b32 v9, v8
    s_sub_u32 s58, s58, 1
    s_cbranch_scc1 GD_12
    s_waitcnt lgkmcnt(0)
    v_readfirstlane_b32 s3, v9
    s_nop 1
    s_cmp_lt_u32 s3, 8
    s_cbranch_scc1 GL_11
GD_12:
    s_waitcnt lgkmcnt(0)
AT_free:
    ds_write_b128 v10, v[16:19] offset:0
    v_mfma_f32_32x32x16_bf16 v[128:143], v[208:211], v[104:107], 0
    v_exp_f32 v144, v112
    v_cvt_pk_bf16_f32 v158, v148, v149
    v_exp_f32 v145, v113
    v_cvt_pk_bf16_f32 v159, v150, v151
    v_exp_f32 v146, v114
    v_exp_f32 v147, v115
    v_mfma_f32_32x32x16_bf16 v[32:47], v[220:223], v[156:159], v[32:47]
    ds_write_b128 v10, v[20:23] offset:1024
    v_exp_f32 v148, v116
    v_cvt_pk_bf16_f32 v152, v144, v145
    v_exp_f32 v149, v117
    v_cvt_pk_bf16_f32 v153, v146, v147
    v_exp_f32 v150, v118
    v_exp_f32 v151, v119
    v_mfma_f32_32x32x16_bf16 v[128:143], v[212:215], v[108:111], v[128:143]
    ds_write_b128 v10, v[24:27] offset:2048
    v_exp_f32 v144, v120
    v_cvt_pk_bf16_f32 v154, v148, v149
    v_exp_f32 v145, v121
    v_cvt_pk_bf16_f32 v155, v150, v151
    v_exp_f32 v146, v122
    v_exp_f32 v147, v123
    v_mfma_f32_32x32x16_bf16 v[48:63], v[216:219], v[152:155], v[48:63]
    v_exp_f32 v148, v124
    v_cvt_pk_bf16_f32 v156, v144, v145
    v_exp_f32 v149, v125
    v_cvt_pk_bf16_f32 v157, v146, v147
    v_exp_f32 v150, v126
    v_exp_f32 v151, v127
    ds_write_b128 v10, v[32:35] offset:3712
    v_exp_f32 v144, v128
    v_cvt_pk_bf16_f32 v158, v148, v149
    v_exp_f32 v145, v129
    v_cvt_pk_bf16_f32 v159, v150, v151
    v_exp_f32 v146, v130
    v_exp_f32 v147, v131
    v_mfma_f32_32x32x16_bf16 v[48:63], v[220:223], v[156:159], v[48:63]
    ds_write_b128 v10, v[36:39] offset:4736
    v_exp_f32 v148, v132
    v_cvt_pk_bf16_f32 v152, v144, v145
    v_exp_f32 v149, v133
    v_cvt_pk_bf16_f32 v153, v146, v147
    v_exp_f32 v150, v134
    v_exp_f32 v151, v135
    ds_write_b128 v10, v[40:43] offset:5760
    v_exp_f32 v144, v136
    v_cvt_pk_bf16_f32 v154, v148, v149
    v_exp_f32 v145, v137
    v_cvt_pk_bf16_f32 v155, v150, v151
    v_exp_f32 v146, v138
    v_exp_f32 v147, v139
    v_mfma_f32_32x32x16_bf16 v[64:79], v[216:219], v[152:155], v[64:79]
    v_exp_f32 v148, v140
    v_cvt_pk_bf16_f32 v156, v144, v145
    v_exp_f32 v149, v141
    v_cvt_pk_bf16_f32 v157, v146, v147
    v_exp_f32 v150, v142
    v_exp_f32 v151, v143
    v_cvt_pk_bf16_f32 v158, v148, v149
    v_cvt_pk_bf16_f32 v159, v150, v151
    ds_write_b128 v10, v[48:51] offset:7424
    ds_write_b128 v10, v[52:55] offset:8448
    ds_write_b128 v10, v[56:59] offset:9472
    v_mfma_f32_32x32x16_bf16 v[64:79], v[220:223], v[156:159], v[64:79]
    s_mov_b64 exec, 0xffffffff
    ds_write_b128 v10, v[28:31] offset:3072
    ds_write_b128 v10, v[44:47] offset:6784
    ds_write_b128 v10, v[60:63] offset:10496
    s_not_b64 exec, exec
    ds_write_b32 v15, v28 offset:0
    ds_write_b32 v15, v44 offset:3712
    ds_write_b32 v15, v60 offset:7424
    s_mov_b64 exec, -1
    s_waitcnt lgkmcnt(0)
    s_mov_b64 exec, 1
    v_mov_b32 v8, 159748
    v_mov_b32 v9, 1
    ds_add_u32 v8, v9
    s_mov_b64 exec, -1
    s_mov_b32 s58, 524288
    v_mov_b32 v8, 159748
GL_13:
    ds_read_b32 v9, v8
    s_sub_u32 s58, s58, 1
    s_cbranch_scc1 GD_14
    s_waitcnt lgkmcnt(0)
    v_readfirstlane_b32 s3, v9
    s_nop 1
    s_cmp_lt_u32 s3, 4
    s_cbranch_scc1 GL_13
GD_14:
    s_waitcnt lgkmcnt(0)
    s_mov_b64 exec, 0xffffffff
    ds_read_b128 v[28:31], v11 offset:3072
    ds_read_b128 v[44:47], v12 offset:6784
    ds_read_b128 v[60:63], v13 offset:10496
    s_not_b64 exec, exec
    ds_read_b32 v28, v5 offset:0
    ds_read_b32 v44, v6 offset:3712
    ds_read_b32 v60, v7 offset:7424
    s_mov_b64 exec, -1
    ds_read_b128 v[16:19], v11 offset:0
    ds_read_b128 v[20:23], v11 offset:1024
    ds_read_b128 v[24:27], v11 offset:2048
    ds_read_b128 v[32:35], v12 offset:3712
    ds_read_b128 v[36:39], v12 offset:4736
    ds_read_b128 v[40:43], v12 offset:5760
    ds_read_b128 v[48:51], v13 offset:7424
    ds_read_b128 v[52:55], v13 offset:8448
    ds_read_b128 v[56:59], v13 offset:9472
    s_waitcnt lgkmcnt(6)
    v_add_f32 v64, v64, v16
    v_add_f32 v65, v65, v17
    v_add_f32 v66, v66, v18
    v_add_f32 v67, v67, v19
    v_add_f32 v68, v68, v20
    v_add_f32 v69, v69, v21
    v_add_f32 v70, v70, v22
    v_add_f32 v71, v71, v23
    v_add_f32 v72, v72, v24
    v_add_f32 v73, v73, v25
    v_add_f32 v74, v74, v26
    v_add_f32 v75, v75, v27
    v_add_f32 v76, v76, v28
    v_add_f32 v77, v77, v29
    v_add_f32 v78, v78, v30
    v_add_f32 v79, v79, v31
    s_waitcnt lgkmcnt(3)
    v_add_f32 v64, v64, v32
    v_add_f32 v65, v65, v33
    v_add_f32 v66, v66, v34
    v_add_f32 v67, v67, v35
    v_add_f32 v68, v68, v36
    v_add_f32 v69, v69, v37
    v_add_f32 v70, v70, v38
    v_add_f32 v71, v71, v39
    v_add_f32 v72, v72, v40
    v_add_f32 v73, v73, v41
    v_add_f32 v74, v74, v42
    v_add_f32 v75, v75, v43
    v_add_f32 v76, v76, v44
    v_add_f32 v77, v77, v45
    v_add_f32 v78, v78, v46
    v_add_f32 v79, v79, v47
    s_waitcnt lgkmcnt(0)
    v_add_f32 v64, v64, v48
    v_add_f32 v65, v65, v49
    v_add_f32 v66, v66, v50
    v_add_f32 v67, v67, v51
    v_add_f32 v68, v68, v52
    v_add_f32 v69, v69, v53
    v_add_f32 v70, v70, v54
    v_add_f32 v71, v71, v55
    v_add_f32 v72, v72, v56
    v_add_f32 v73, v73, v57
    v_add_f32 v74, v74, v58
    v_add_f32 v75, v75, v59
    v_add_f32 v76, v76, v60
    v_add_f32 v77, v77, v61
    v_add_f32 v78, v78, v62
    v_add_f32 v79, v79, v63
    v_mov_b32 v10, v76
    v_mov_b32 v11, v76
    s_nop 1
    v_permlane32_swap_b32 v11, v10
    v_mov_b32 v12, v10
    v_mov_b32 v13, 0
    v_fma_f32 v12, v64, 0, v12
    v_fma_f32 v13, v65, 0, v13
    v_fma_f32 v12, v66, 0, v12
    v_fma_f32 v13, v67, 0, v13
    v_fma_f32 v12, v68, 0, v12
    v_fma_f32 v13, v69, 0, v13
    v_fma_f32 v12, v70, 0, v12
    v_fma_f32 v13, v71, 0, v13
    v_fma_f32 v12, v72, 0, v12
    v_fma_f32 v13, v73, 0, v13
    v_fma_f32 v12, v74, 0, v12
    v_fma_f32 v13, v75, 0, v13
    v_fma_f32 v12, v76, 0, v12
    v_fma_f32 v13, v77, 0, v13
    v_fma_f32 v12, v78, 0, v12
    v_fma_f32 v13, v79, 0, v13
    v_add_f32 v12, v12, v13
    v_cmp_le_f32 vcc, 0x17800000, v12
    v_cmp_ge_f32 s[26:27], s59, v12
    s_nop 1
    s_and_b64 vcc, vcc, s[26:27]
    s_cmp_eq_u64 vcc, -1
    s_cbranch_scc0 AT_slow
AT_norm:
    v_rcp_f32 v10, v10
    v_lshrrev_b32 v8, 5, v1
    v_add_u32 v8, -1, v8
    s_nop 1
    v_mul_f32 v64, v64, v10
    v_mul_f32 v65, v65, v10
    v_mul_f32 v66, v66, v10
    v_mul_f32 v67, v67, v10
    v_mul_f32 v68, v68, v10
    v_mul_f32 v69, v69, v10
    v_mul_f32 v70, v70, v10
    v_mul_f32 v71, v71, v10
    v_mul_f32 v72, v72, v10
    v_mul_f32 v73, v73, v10
    v_mul_f32 v74, v74, v10
    v_mul_f32 v75, v75, v10
    v_mul_f32 v76, v76, v10
    v_mul_f32 v77, v77, v10
    v_mul_f32 v78, v78, v10
    v_mul_f32 v79, v79, v10
    v_cvt_pk_bf16_f32 v152, v64, v65
    v_cvt_pk_bf16_f32 v153, v66, v67
    v_cvt_pk_bf16_f32 v154, v68, v69
    v_cvt_pk_bf16_f32 v155, v70, v71
    v_cvt_pk_bf16_f32 v156, v72, v73
    v_cvt_pk_bf16_f32 v157, v74, v75
    v_cvt_pk_bf16_f32 v158, v76, v77
    v_cvt_pk_bf16_f32 v159, v78, v79
    v_and_b32 v158, v8, v158
    v_and_b32 v159, v8, v159
    buffer_store_dwordx4 v[152:155], v0, s[36:39], s62 offen sc1
    buffer_store_dwordx4 v[156:159], v0, s[36:39], s62 offen offset:1024 sc1
    s_waitcnt vmcnt(0)
    s_mov_b64 exec, 1
    v_mov_b32 v8, 159764
    v_mov_b32 v9, 1
    ds_add_rtn_u32 v8, v8, v9
    s_waitcnt lgkmcnt(0)
    v_readfirstlane_b32 s26, v8
    v_mov_b32 v8, 0
    s_nop 0
    s_cmp_eq_u32 s26, 3
    s_cselect_b32 s26, s63, 2147483648
    s_nop 0
    buffer_store_dword v9, v8, s[36:39], s26 offen sc1
    s_mov_b64 exec, -1
    s_endpgm
AT_late:
    s_mov_b32 s58, 65536
    s_bfm_b64 exec, 8, 0
PL_15:
    buffer_load_dword v9, v2, s[36:39], 0 offen sc1
    s_waitcnt vmcnt(0)
    v_cmp_eq_u32 vcc, 0, v9
    s_nop 1
    s_cbranch_vccz PD_16
    s_sleep 1
    s_sub_u32 s58, s58, 1
    s_cmp_lg_u32 s58, 0
    s_cbranch_scc1 PL_15
PD_16:
    s_mov_b64 exec, -1
    s_branch AT_ok
AT_slow:
    s_waitcnt vmcnt(0)
    s_mul_i32 s52, s44, 229376
    s_add_u32 s52, s52, 2097152
    s_mov_b32 s50, s52
    s_mov_b32 s51, 64
    v_mov_b32 v12, 0xff800000
AT_s1:
    buffer_load_dwordx4 v[160:163], v0, s[36:39], s50 offen sc1
    buffer_load_dwordx3 v[164:166], v4, s[36:39], s50 offen offset:1024 sc1
    s_add_u32 s50, s50, 3584
    s_waitcnt vmcnt(0)
    v_mfma_f32_32x32x16_bf16 v[112:127], v[160:163], v[104:107], 0
    v_mfma_f32_32x32x16_bf16 v[112:127], v[164:167], v[108:111], v[112:127]
    s_nop 11
    v_max3_f32 v12, v12, v112, v113
    v_max3_f32 v12, v12, v114, v115
    v_max3_f32 v12, v12, v116, v117
    v_max3_f32 v12, v12, v118, v119
    v_max3_f32 v12, v12, v120, v121
    v_max3_f32 v12, v12, v122, v123
    v_max3_f32 v12, v12, v124, v125
    v_max3_f32 v12, v12, v126, v127
    s_sub_u32 s51, s51, 1
    s_cmp_lg_u32 s51, 0
    s_cbranch_scc1 AT_s1
    v_mov_b32 v13, v12
    s_nop 1
    v_permlane32_swap_b32 v12, v13
    v_max_f32 v12, v12, v13
    v_cvt_pk_bf16_f32 v13, -v12, -v12
    v_and_b32 v13, 0xffff0000, v13
    v_sub_f32 v12, -v12, v13
    v_cvt_pk_bf16_f32 v14, v12, v12
    v_and_b32 v14, 0xffff0000, v14
    v_sub_f32 v12, v12, v14
    v_cvt_pk_bf16_f32 v13, v13, v14
    v_cvt_pk_bf16_f32 v14, v12, 0
    v_lshrrev_b32 v8, 5, v1
    v_add_u32 v8, -1, v8
    v_bfi_b32 v111, v8, v13, v14
    s_mov_b32 s50, s52
    s_mov_b32 s51, 64
    v_mov_b32 v64, 0
    v_mov_b32 v65, 0
    v_mov_b32 v66, 0
    v_mov_b32 v67, 0
    v_mov_b32 v68, 0
    v_mov_b32 v69, 0
    v_mov_b32 v70, 0
    v_mov_b32 v71, 0
    v_mov_b32 v72, 0
    v_mov_b32 v73, 0
    v_mov_b32 v74, 0
    v_mov_b32 v75, 0
    v_mov_b32 v76, 0
    v_mov_b32 v77, 0
    v_mov_b32 v78, 0
    v_mov_b32 v79, 0
AT_s2:
    buffer_load_dwordx4 v[160:163], v0, s[36:39], s50 offen sc1
    buffer_load_dwordx3 v[164:166], v4, s[36:39], s50 offen offset:1024 sc1
    s_mov_b64 exec, s[54:55]
    buffer_load_dwordx4 v[168:171], v224, s[36:39], s50 offen offset:1792 sc1
    buffer_load_dwordx4 v[172:175], v224, s[36:39], s50 offen offset:2688 sc1
    s_mov_b64 exec, -1
    s_add_u32 s50, s50, 3584
    s_waitcnt vmcnt(0)
    v_mfma_f32_32x32x16_bf16 v[112:127], v[160:163], v[104:107], 0
    v_mfma_f32_32x32x16_bf16 v[112:127], v[164:167], v[108:111], v[112:127]
    s_nop 11
    v_exp_f32 v112, v112
    v_exp_f32 v113, v113
    v_exp_f32 v114, v114
    v_exp_f32 v115, v115
    v_exp_f32 v116, v116
    v_exp_f32 v117, v117
    v_exp_f32 v118, v118
    v_exp_f32 v119, v119
    v_exp_f32 v120, v120
    v_exp_f32 v121, v121
    v_exp_f32 v122, v122
    v_exp_f32 v123, v123
    v_exp_f32 v124, v124
    v_exp_f32 v125, v125
    v_exp_f32 v126, v126
    v_exp_f32 v127, v127
    v_cvt_pk_bf16_f32 v152, v112, v113
    v_cvt_pk_bf16_f32 v153, v114, v115
    v_cvt_pk_bf16_f32 v154, v116, v117
    v_cvt_pk_bf16_f32 v155, v118, v119
    v_cvt_pk_bf16_f32 v156, v120, v121
    v_cvt_pk_bf16_f32 v157, v122, v123
    v_cvt_pk_bf16_f32 v158, v124, v125
    v_cvt_pk_bf16_f32 v159, v126, v127
    v_mfma_f32_32x32x16_bf16 v[64:79], v[168:171], v[152:155], v[64:79]
    s_nop 0
    v_mfma_f32_32x32x16_bf16 v[64:79], v[172:175], v[156:159], v[64:79]
    s_sub_u32 s51, s51, 1
    s_cmp_lg_u32 s51, 0
    s_cbranch_scc1 AT_s2
    s_nop 8
    v_mov_b32 v10, v76
    v_mov_b32 v11, v76
    s_nop 1
    v_permlane32_swap_b32 v11, v10
    s_branch AT_norm
K_roleb:
    s_cmp_ge_u32 s2, 224
    s_cbranch_scc0 B_go
    s_mov_b64 exec, 1
    v_mov_b32 v8, 159744
    v_mov_b32 v9, 6
    ds_add_u32 v8, v9
    s_mov_b64 exec, -1
    s_mov_b64 exec, 1
    v_mov_b32 v8, 159772
    v_mov_b32 v9, 1
    ds_add_u32 v8, v9
    s_mov_b64 exec, -1
    s_lshl_b32 s3, s44, 10
    s_add_u32 s3, s3, 22380544
    v_mov_b32 v10, s3
    s_mov_b32 s58, 65536
    s_mov_b64 exec, 1
PL_17:
    buffer_load_dword v9, v10, s[36:39], 0 offen sc1
    s_waitcnt vmcnt(0)
    v_cmp_eq_u32 vcc, 0, v9
    s_nop 1
    s_cbranch_vccz PD_18
    s_sleep 1
    s_sub_u32 s58, s58, 1
    s_cmp_lg_u32 s58, 0
    s_cbranch_scc1 PL_17
PD_18:
    s_mov_b64 exec, -1
    s_mov_b32 s32, s18
    s_mov_b32 s33, s19
    s_mov_b32 s34, 1605632
    s_mov_b32 s35, 0x20000
    s_mov_b32 s40, s8
    s_mov_b32 s41, s9
    s_mov_b32 s42, 401408
    s_mov_b32 s43, 0x20000
    s_lshr_b32 s3, s2, 3
    s_sub_u32 s3, s3, 28
    s_lshl_b32 s3, s3, 2
    s_add_u32 s3, s3, s46
    s_lshl_b32 s26, s3, 13
    s_and_b32 s27, s2, 1
    s_mul_i32 s27, s27, 802816
    s_add_u32 s26, s26, s27
    v_lshlrev_b32 v8, 7, v1
    s_mov_b32 s27, 7
B_pf:
    buffer_load_dword v16, v8, s[32:35], s26 offen
    s_add_u32 s26, s26, 131072
    s_waitcnt vmcnt(1)
    s_sub_u32 s27, s27, 1
    s_cmp_lg_u32 s27, 0
    s_cbranch_scc1 B_pf
    s_lshl_b32 s26, s3, 13
    buffer_load_dword v16, v8, s[40:43], s26 offen
    s_add_u32 s26, s26, 131072
    buffer_load_dword v16, v8, s[40:43], s26 offen
    s_add_u32 s26, s26, 131072
    buffer_load_dword v16, v8, s[40:43], s26 offen
    s_add_u32 s26, s26, 131072
    buffer_load_dword v16, v8, s[40:43], s26 offen
    s_add_u32 s26, s26, 131072
    s_endpgm
B_go:
    s_setprio 1
    s_lshl_b32 s3, s52, 12
    s_sub_u32 s3, s3, s49
    v_add_u32 v4, s3, v2
    v_add_u32 v5, s3, v3
    s_mov_b32 s58, 65536
    s_mov_b64 exec, 3
PL_19:
    buffer_load_dword v9, v188, s[36:39], 0 offen sc1
    s_waitcnt vmcnt(0)
    v_cmp_eq_u32 vcc, 0, v9
    s_nop 1
    s_cbranch_vccz PD_20
    s_sleep 6
    s_sub_u32 s58, s58, 1
    s_cmp_lg_u32 s58, 0
    s_cbranch_scc1 PL_19
PD_20:
    s_mov_b64 exec, -1
    s_mov_b64 exec, 1
    v_mov_b32 v8, 159768
    v_mov_b32 v9, 1
    ds_add_u32 v8, v9
    s_mov_b64 exec, -1
    buffer_load_dword v12, v189, s[36:39], 0 offen sc1
    buffer_load_dwordx4 v[112:115], v186, s[36:39], s51 offen sc1
    buffer_load_dwordx4 v[116:119], v187, s[36:39], s51 offen sc1
    s_add_u32 s51, s51, 1024
    s_cmp_eq_u32 s51, 7168
    s_cselect_b32 s51, 0, s51
    buffer_load_dwordx4 v[120:123], v186, s[36:39], s51 offen sc1
    buffer_load_dwordx4 v[124:127], v187, s[36:39], s51 offen sc1
    s_add_u32 s51, s51, 1024
    s_cmp_eq_u32 s51, 7168
    s_cselect_b32 s51, 0, s51
    buffer_load_dwordx4 v[128:131], v186, s[36:39], s51 offen sc1
    buffer_load_dwordx4 v[132:135], v187, s[36:39], s51 offen sc1
    s_add_u32 s51, s51, 1024
    s_cmp_eq_u32 s51, 7168
    s_cselect_b32 s51, 0, s51
    buffer_load_dwordx4 v[136:139], v186, s[36:39], s51 offen sc1
    buffer_load_dwordx4 v[140:143], v187, s[36:39], s51 offen sc1
    s_add_u32 s51, s51, 1024
    s_cmp_eq_u32 s51, 7168
    s_cselect_b32 s51, 0, s51
    buffer_load_dwordx4 v[144:147], v186, s[36:39], s51 offen sc1
    buffer_load_dwordx4 v[148:151], v187, s[36:39], s51 offen sc1
    s_add_u32 s51, s51, 1024
    s_cmp_eq_u32 s51, 7168
    s_cselect_b32 s51, 0, s51
    buffer_load_dwordx4 v[152:155], v186, s[36:39], s51 offen sc1
    buffer_load_dwordx4 v[156:159], v187, s[36:39], s51 offen sc1
    s_add_u32 s51, s51, 1024
    s_cmp_eq_u32 s51, 7168
    s_cselect_b32 s51, 0, s51
    buffer_load_dwordx4 v[160:163], v186, s[36:39], s51 offen sc1
    buffer_load_dwordx4 v[164:167], v187, s[36:39], s51 offen sc1
    s_waitcnt vmcnt(14)
    v_cmp_eq_u32 vcc, 0, v12
    s_nop 1
    s_cbranch_vccz B_st1
    s_mov_b32 s58, 65536
    s_mov_b64 exec, 1
PL_21:
    buffer_load_dword v9, v189, s[36:39], 0 offen sc1
    s_waitcnt vmcnt(0)
    v_cmp_eq_u32 vcc, 0, v9
    s_nop 1
    s_cbranch_vccz PD_22
    s_sleep 1
    s_sub_u32 s58, s58, 1
    s_cmp_lg_u32 s58, 0
    s_cbranch_scc1 PL_21
PD_22:
    s_mov_b64 exec, -1
B_st1:
    buffer_load_dwordx2 v[184:185], v15, s[36:39], s27 offen sc1
    s_mov_b64 exec, 1
    v_mov_b32 v8, 159772
    v_mov_b32 v9, 1
    ds_add_u32 v8, v9
    s_mov_b64 exec, -1
    s_setprio 1
    s_mov_b32 s58, 524288
    v_mov_b32 v8, 159768
GL_23:
    ds_read_b32 v9, v8
    s_sub_u32 s58, s58, 1
    s_cbranch_scc1 GD_24
    s_waitcnt lgkmcnt(0)
    v_readfirstlane_b32 s3, v9
    s_nop 1
    s_bfe_u32 s3, s3, 262144
    s_cmp_lt_u32 s3, 4
    s_cbranch_scc1 GL_23
GD_24:
    s_waitcnt lgkmcnt(0)
    ds_read_b64_tr_b16 v[80:81], v4 offset:0
    ds_read_b64_tr_b16 v[82:83], v4 offset:1024
    ds_read_b64_tr_b16 v[84:85], v5 offset:0
    ds_read_b64_tr_b16 v[86:87], v5 offset:1024
    ds_read_b64_tr_b16 v[88:89], v4 offset:2048
    ds_read_b64_tr_b16 v[90:91], v4 offset:3072
    ds_read_b64_tr_b16 v[92:93], v5 offset:2048
    ds_read_b64_tr_b16 v[94:95], v5 offset:3072
    ds_read_b64_tr_b16 v[96:97], v4 offset:8192
    ds_read_b64_tr_b16 v[98:99], v4 offset:9216
    ds_read_b64_tr_b16 v[100:101], v5 offset:8192
    ds_read_b64_tr_b16 v[102:103], v5 offset:9216
    s_waitcnt vmcnt(14) lgkmcnt(8)
    v_mfma_f32_32x32x16_bf16 v[16:31], v[80:83], v[112:115], 0
    v_mfma_f32_32x32x16_bf16 v[32:47], v[84:87], v[112:115], 0
    ds_read_b64_tr_b16 v[104:105], v4 offset:10240
    ds_read_b64_tr_b16 v[106:107], v4 offset:11264
    ds_read_b64_tr_b16 v[108:109], v5 offset:10240
    ds_read_b64_tr_b16 v[110:111], v5 offset:11264
    s_waitcnt vmcnt(13) lgkmcnt(8)
    v_mfma_f32_32x32x16_bf16 v[16:31], v[88:91], v[116:119], v[16:31]
    v_mfma_f32_32x32x16_bf16 v[32:47], v[92:95], v[116:119], v[32:47]
    ds_read_b64_tr_b16 v[80:81], v4 offset:16384
    ds_read_b64_tr_b16 v[82:83], v4 offset:17408
    ds_read_b64_tr_b16 v[84:85], v5 offset:16384
    ds_read_b64_tr_b16 v[86:87], v5 offset:17408
    s_waitcnt vmcnt(12) lgkmcnt(8)
    v_mfma_f32_32x32x16_bf16 v[16:31], v[96:99], v[120:123], v[16:31]
    v_mfma_f32_32x32x16_bf16 v[32:47], v[100:103], v[120:123], v[32:47]
    ds_read_b64_tr_b16 v[88:89], v4 offset:18432
    ds_read_b64_tr_b16 v[90:91], v4 offset:19456
    ds_read_b64_tr_b16 v[92:93], v5 offset:18432
    ds_read_b64_tr_b16 v[94:95], v5 offset:19456
    s_waitcnt vmcnt(11) lgkmcnt(8)
    v_mfma_f32_32x32x16_bf16 v[16:31], v[104:107], v[124:127], v[16:31]
    v_mfma_f32_32x32x16_bf16 v[32:47], v[108:111], v[124:127], v[32:47]
    ds_read_b64_tr_b16 v[96:97], v4 offset:24576
    ds_read_b64_tr_b16 v[98:99], v4 offset:25600
    ds_read_b64_tr_b16 v[100:101], v5 offset:24576
    ds_read_b64_tr_b16 v[102:103], v5 offset:25600
    s_waitcnt vmcnt(10) lgkmcnt(8)
    v_mfma_f32_32x32x16_bf16 v[16:31], v[80:83], v[128:131], v[16:31]
    v_mfma_f32_32x32x16_bf16 v[32:47], v[84:87], v[128:131], v[32:47]
    ds_read_b64_tr_b16 v[104:105], v4 offset:26624
    ds_read_b64_tr_b16 v[106:107], v4 offset:27648
    ds_read_b64_tr_b16 v[108:109], v5 offset:26624
    ds_read_b64_tr_b16 v[110:111], v5 offset:27648
    s_waitcnt vmcnt(9) lgkmcnt(8)
    v_mfma_f32_32x32x16_bf16 v[16:31], v[88:91], v[132:135], v[16:31]
    v_mfma_f32_32x32x16_bf16 v[32:47], v[92:95], v[132:135], v[32:47]
    ds_read_b64_tr_b16 v[80:81], v4 offset:32768
    ds_read_b64_tr_b16 v[82:83], v4 offset:33792
    ds_read_b64_tr_b16 v[84:85], v5 offset:32768
    ds_read_b64_tr_b16 v[86:87], v5 offset:33792
    s_waitcnt vmcnt(8) lgkmcnt(8)
    v_mfma_f32_32x32x16_bf16 v[16:31], v[96:99], v[136:139], v[16:31]
    v_mfma_f32_32x32x16_bf16 v[32:47], v[100:103], v[136:139], v[32:47]
    ds_read_b64_tr_b16 v[88:89], v4 offset:34816
    ds_read_b64_tr_b16 v[90:91], v4 offset:35840
    ds_read_b64_tr_b16 v[92:93], v5 offset:34816
    ds_read_b64_tr_b16 v[94:95], v5 offset:35840
    s_waitcnt vmcnt(7) lgkmcnt(8)
    v_mfma_f32_32x32x16_bf16 v[16:31], v[104:107], v[140:143], v[16:31]
    v_mfma_f32_32x32x16_bf16 v[32:47], v[108:111], v[140:143], v[32:47]
    ds_read_b64_tr_b16 v[96:97], v4 offset:40960
    ds_read_b64_tr_b16 v[98:99], v4 offset:41984
    ds_read_b64_tr_b16 v[100:101], v5 offset:40960
    ds_read_b64_tr_b16 v[102:103], v5 offset:41984
    s_waitcnt vmcnt(6) lgkmcnt(8)
    v_mfma_f32_32x32x16_bf16 v[16:31], v[80:83], v[144:147], v[16:31]
    v_mfma_f32_32x32x16_bf16 v[32:47], v[84:87], v[144:147], v[32:47]
    ds_read_b64_tr_b16 v[104:105], v4 offset:43008
    ds_read_b64_tr_b16 v[106:107], v4 offset:44032
    ds_read_b64_tr_b16 v[108:109], v5 offset:43008
    ds_read_b64_tr_b16 v[110:111], v5 offset:44032
    s_waitcnt vmcnt(5) lgkmcnt(8)
    v_mfma_f32_32x32x16_bf16 v[16:31], v[88:91], v[148:151], v[16:31]
    v_mfma_f32_32x32x16_bf16 v[32:47], v[92:95], v[148:151], v[32:47]
    ds_read_b64_tr_b16 v[80:81], v4 offset:49152
    ds_read_b64_tr_b16 v[82:83], v4 offset:50176
    ds_read_b64_tr_b16 v[84:85], v5 offset:49152
    ds_read_b64_tr_b16 v[86:87], v5 offset:50176
    s_waitcnt vmcnt(4) lgkmcnt(8)
    v_mfma_f32_32x32x16_bf16 v[16:31], v[96:99], v[152:155], v[16:31]
    v_mfma_f32_32x32x16_bf16 v[32:47], v[100:103], v[152:155], v[32:47]
    ds_read_b64_tr_b16 v[88:89], v4 offset:51200
    ds_read_b64_tr_b16 v[90:91], v4 offset:52224
    ds_read_b64_tr_b16 v[92:93], v5 offset:51200
    ds_read_b64_tr_b16 v[94:95], v5 offset:52224
    s_waitcnt vmcnt(3) lgkmcnt(8)
    v_mfma_f32_32x32x16_bf16 v[16:31], v[104:107], v[156:159], v[16:31]
    v_mfma_f32_32x32x16_bf16 v[32:47], v[108:111], v[156:159], v[32:47]
    s_waitcnt vmcnt(2) lgkmcnt(4)
    v_mfma_f32_32x32x16_bf16 v[16:31], v[80:83], v[160:163], v[16:31]
    v_mfma_f32_32x32x16_bf16 v[32:47], v[84:87], v[160:163], v[32:47]
    s_waitcnt vmcnt(1) lgkmcnt(0)
    v_mfma_f32_32x32x16_bf16 v[16:31], v[88:91], v[164:167], v[16:31]
    v_mfma_f32_32x32x16_bf16 v[32:47], v[92:95], v[164:167], v[32:47]
    s_setprio 1
    s_nop 10
    ds_write_b128 v190, v[32:35] offset:0
    ds_write_b128 v190, v[36:39] offset:1024
    ds_write_b128 v190, v[40:43] offset:2048
    ds_write_b128 v190, v[44:47] offset:3072
    s_waitcnt lgkmcnt(0)
    s_mov_b64 exec, 1
    v_mov_b32 v8, 159744
    v_mov_b32 v9, 1
    ds_add_u32 v8, v9
    s_mov_b64 exec, -1
    s_waitcnt vmcnt(0)
    v_sub_f32 v112, v224, v184
    v_sub_f32 v113, v225, v184
    v_sub_f32 v114, v226, v184
    v_sub_f32 v115, v227, v184
    v_sub_f32 v116, v228, v184
    v_sub_f32 v117, v229, v184
    v_sub_f32 v118, v230, v184
    v_sub_f32 v119, v231, v184
    v_sub_f32 v120, v232, v184
    v_sub_f32 v121, v233, v184
    v_sub_f32 v122, v234, v184
    v_sub_f32 v123, v235, v184
    v_sub_f32 v124, v236, v184
    v_sub_f32 v125, v237, v184
    v_sub_f32 v126, v238, v184
    v_sub_f32 v127, v239, v184
    s_mov_b32 s58, 524288
    v_mov_b32 v8, 159744
GL_25:
    ds_read_b32 v9, v8
    s_sub_u32 s58, s58, 1
    s_cbranch_scc1 GD_26
    s_waitcnt lgkmcnt(0)
    v_readfirstlane_b32 s3, v9
    s_nop 1
    s_cmp_lt_u32 s3, 4
    s_cbranch_scc1 GL_25
GD_26:
    s_waitcnt lgkmcnt(0)
    ds_read_b128 v[32:35], v191 offset:0
    ds_read_b128 v[36:39], v191 offset:1024
    ds_read_b128 v[40:43], v191 offset:2048
    ds_read_b128 v[44:47], v191 offset:3072
    s_waitcnt lgkmcnt(3)
    v_add_f32 v16, v16, v32
    v_add_f32 v17, v17, v33
    v_add_f32 v18, v18, v34
    v_add_f32 v19, v19, v35
    s_waitcnt lgkmcnt(2)
    v_add_f32 v20, v20, v36
    v_add_f32 v21, v21, v37
    v_add_f32 v22, v22, v38
    v_add_f32 v23, v23, v39
    s_waitcnt lgkmcnt(1)
    v_add_f32 v24, v24, v40
    v_add_f32 v25, v25, v41
    v_add_f32 v26, v26, v42
    v_add_f32 v27, v27, v43
    s_waitcnt lgkmcnt(0)
    v_add_f32 v28, v28, v44
    v_add_f32 v29, v29, v45
    v_add_f32 v30, v30, v46
    v_add_f32 v31, v31, v47
    v_fma_f32 v112, v112, v185, v16
    v_fma_f32 v113, v113, v185, v17
    v_fma_f32 v114, v114, v185, v18
    v_fma_f32 v115, v115, v185, v19
    v_fma_f32 v116, v116, v185, v20
    v_fma_f32 v117, v117, v185, v21
    v_fma_f32 v118, v118, v185, v22
    v_fma_f32 v119, v119, v185, v23
    v_fma_f32 v120, v120, v185, v24
    v_fma_f32 v121, v121, v185, v25
    v_fma_f32 v122, v122, v185, v26
    v_fma_f32 v123, v123, v185, v27
    v_fma_f32 v124, v124, v185, v28
    v_fma_f32 v125, v125, v185, v29
    v_fma_f32 v126, v126, v185, v30
    v_fma_f32 v127, v127, v185, v31
    v_cvt_pk_bf16_f32 v176, v112, v113
    v_cvt_pk_bf16_f32 v177, v114, v115
    v_cvt_pk_bf16_f32 v178, v116, v117
    v_cvt_pk_bf16_f32 v179, v118, v119
    v_cvt_pk_bf16_f32 v180, v120, v121
    v_cvt_pk_bf16_f32 v181, v122, v123
    v_cvt_pk_bf16_f32 v182, v124, v125
    v_cvt_pk_bf16_f32 v183, v126, v127
    buffer_store_dwordx4 v[176:179], v0, s[36:39], s53 offen sc1
    buffer_store_dwordx4 v[180:183], v0, s[36:39], s53 offen offset:1024 sc1
    v_add_f32 v10, v112, 0
    v_fma_f32 v12, v112, v112, 0
    v_add_f32 v11, v113, 0
    v_fma_f32 v13, v113, v113, 0
    v_add_f32 v10, v114, v10
    v_fma_f32 v12, v114, v114, v12
    v_add_f32 v11, v115, v11
    v_fma_f32 v13, v115, v115, v13
    v_add_f32 v10, v116, v10
    v_fma_f32 v12, v116, v116, v12
    v_add_f32 v11, v117, v11
    v_fma_f32 v13, v117, v117, v13
    v_add_f32 v10, v118, v10
    v_fma_f32 v12, v118, v118, v12
    v_add_f32 v11, v119, v11
    v_fma_f32 v13, v119, v119, v13
    v_add_f32 v10, v120, v10
    v_fma_f32 v12, v120, v120, v12
    v_add_f32 v11, v121, v11
    v_fma_f32 v13, v121, v121, v13
    v_add_f32 v10, v122, v10
    v_fma_f32 v12, v122, v122, v12
    v_add_f32 v11, v123, v11
    v_fma_f32 v13, v123, v123, v13
    v_add_f32 v10, v124, v10
    v_fma_f32 v12, v124, v124, v12
    v_add_f32 v11, v125, v11
    v_fma_f32 v13, v125, v125, v13
    v_add_f32 v10, v126, v10
    v_fma_f32 v12, v126, v126, v12
    v_add_f32 v11, v127, v11
    v_fma_f32 v13, v127, v127, v13
    v_add_f32 v10, v10, v11
    v_add_f32 v11, v12, v13
    v_mov_b32 v8, v10
    s_nop 1
    v_permlane32_swap_b32 v10, v8
    v_add_f32 v10, v10, v8
    v_mov_b32 v9, v11
    s_nop 1
    v_permlane32_swap_b32 v11, v9
    v_add_f32 v11, v11, v9
    buffer_store_dwordx2 v[10:11], v15, s[36:39], s62 offen sc1
    s_mov_b32 s53, s63
    s_mov_b64 exec, 1
    v_mov_b32 v8, 159744
    v_mov_b32 v9, 1
    ds_add_u32 v8, v9
    s_mov_b64 exec, -1
    v_add_f32 v224, v224, v112
    v_add_f32 v225, v225, v113
    v_add_f32 v226, v226, v114
    v_add_f32 v227, v227, v115
    v_add_f32 v228, v228, v116
    v_add_f32 v229, v229, v117
    v_add_f32 v230, v230, v118
    v_add_f32 v231, v231, v119
    v_add_f32 v232, v232, v120
    v_add_f32 v233, v233, v121
    v_add_f32 v234, v234, v122
    v_add_f32 v235, v235, v123
    v_add_f32 v236, v236, v124
    v_add_f32 v237, v237, v125
    v_add_f32 v238, v238, v126
    v_add_f32 v239, v239, v127
    s_add_u32 m0, s49, 57344
    s_add_u32 s3, s57, 128
    buffer_load_dwordx4 v6, s[40:43], s3 offen lds
    s_add_u32 m0, s49, 58368
    s_add_u32 s3, s57, 28800
    buffer_load_dwordx4 v6, s[40:43], s3 offen lds
    s_add_u32 s57, s57, 229376
    s_cmp_eq_u32 s57, 1605632
    s_cselect_b32 s57, 0, s57
    s_add_u32 m0, s49, 65536
    s_add_u32 s3, s57, 128
    buffer_load_dwordx4 v6, s[40:43], s3 offen lds
    s_add_u32 m0, s49, 66560
    s_add_u32 s3, s57, 28800
    buffer_load_dwordx4 v6, s[40:43], s3 offen lds
    s_add_u32 s57, s57, 229376
    s_cmp_eq_u32 s57, 1605632
    s_cselect_b32 s57, 0, s57
    s_add_u32 m0, s49, 73728
    s_add_u32 s3, s57, 128
    buffer_load_dwordx4 v6, s[40:43], s3 offen lds
    s_add_u32 m0, s49, 74752
    s_add_u32 s3, s57, 28800
    buffer_load_dwordx4 v6, s[40:43], s3 offen lds
    s_add_u32 s57, s57, 229376
    s_cmp_eq_u32 s57, 1605632
    s_cselect_b32 s57, 0, s57
    s_add_u32 m0, s49, 81920
    s_add_u32 s3, s57, 128
    buffer_load_dwordx4 v6, s[40:43], s3 offen lds
    s_add_u32 m0, s49, 82944
    s_add_u32 s3, s57, 28800
    buffer_load_dwordx4 v6, s[40:43], s3 offen lds
    s_add_u32 s57, s57, 229376
    s_cmp_eq_u32 s57, 1605632
    s_cselect_b32 s57, 0, s57
    s_add_u32 m0, s49, 90112
    s_add_u32 s3, s57, 128
    buffer_load_dwordx4 v6, s[40:43], s3 offen lds
    s_add_u32 m0, s49, 91136
    s_add_u32 s3, s57, 28800
    buffer_load_dwordx4 v6, s[40:43], s3 offen lds
    s_add_u32 s57, s57, 229376
    s_cmp_eq_u32 s57, 1605632
    s_cselect_b32 s57, 0, s57
    s_waitcnt vmcnt(10)
    s_mov_b64 exec, 1
    v_mov_b32 v8, 159756
    v_mov_b32 v9, 1
    ds_add_rtn_u32 v8, v8, v9
    s_waitcnt lgkmcnt(0)
    v_readfirstlane_b32 s26, v8
    v_mov_b32 v8, 0
    s_nop 0
    s_cmp_eq_u32 s26, 3
    s_cselect_b32 s26, s53, 2147483648
    s_nop 0
    buffer_store_dword v9, v8, s[36:39], s26 offen sc1
    s_mov_b64 exec, -1
    s_mov_b32 s58, 524288
    v_mov_b32 v8, 159744
GL_27:
    ds_read_b32 v9, v8
    s_sub_u32 s58, s58, 1
    s_cbranch_scc1 GD_28
    s_waitcnt lgkmcnt(0)
    v_readfirstlane_b32 s3, v9
    s_nop 1
    s_cmp_lt_u32 s3, 8
    s_cbranch_scc1 GL_27
GD_28:
    s_waitcnt lgkmcnt(0)
    s_add_u32 m0, s49, 98304
    s_add_u32 s3, s57, 128
    buffer_load_dwordx4 v6, s[40:43], s3 offen lds
    s_add_u32 m0, s49, 99328
    s_add_u32 s3, s57, 28800
    buffer_load_dwordx4 v6, s[40:43], s3 offen lds
    s_add_u32 s57, s57, 229376
    s_cmp_eq_u32 s57, 1605632
    s_cselect_b32 s57, 0, s57
    s_add_u32 m0, s49, 106496
    s_add_u32 s3, s57, 128
    buffer_load_dwordx4 v6, s[40:43], s3 offen lds
    s_add_u32 m0, s49, 107520
    s_add_u32 s3, s57, 28800
    buffer_load_dwordx4 v6, s[40:43], s3 offen lds
    s_add_u32 s57, s57, 229376
    s_cmp_eq_u32 s57, 1605632
    s_cselect_b32 s57, 0, s57
    s_add_u32 m0, s49, 0
    s_add_u32 s3, s57, 0
    buffer_load_dwordx4 v6, s[40:43], s3 offen lds
    s_add_u32 m0, s49, 1024
    s_add_u32 s3, s57, 28672
    buffer_load_dwordx4 v6, s[40:43], s3 offen lds
    s_add_u32 s57, s57, 229376
    s_cmp_eq_u32 s57, 1605632
    s_cselect_b32 s57, 0, s57
    s_add_u32 m0, s49, 8192
    s_add_u32 s3, s57, 0
    buffer_load_dwordx4 v6, s[40:43], s3 offen lds
    s_add_u32 m0, s49, 9216
    s_add_u32 s3, s57, 28672
    buffer_load_dwordx4 v6, s[40:43], s3 offen lds
    s_add_u32 s57, s57, 229376
    s_cmp_eq_u32 s57, 1605632
    s_cselect_b32 s57, 0, s57
    s_add_u32 m0, s49, 16384
    s_add_u32 s3, s57, 0
    buffer_load_dwordx4 v6, s[40:43], s3 offen lds
    s_add_u32 m0, s49, 17408
    s_add_u32 s3, s57, 28672
    buffer_load_dwordx4 v6, s[40:43], s3 offen lds
    s_add_u32 s57, s57, 229376
    s_cmp_eq_u32 s57, 1605632
    s_cselect_b32 s57, 0, s57
    s_add_u32 m0, s49, 24576
    s_add_u32 s3, s57, 0
    buffer_load_dwordx4 v6, s[40:43], s3 offen lds
    s_add_u32 m0, s49, 25600
    s_add_u32 s3, s57, 28672
    buffer_load_dwordx4 v6, s[40:43], s3 offen lds
    s_add_u32 s57, s57, 229376
    s_cmp_eq_u32 s57, 1605632
    s_cselect_b32 s57, 0, s57
    s_add_u32 m0, s49, 32768
    s_add_u32 s3, s57, 0
    buffer_load_dwordx4 v6, s[40:43], s3 offen lds
    s_add_u32 m0, s49, 33792
    s_add_u32 s3, s57, 28672
    buffer_load_dwordx4 v6, s[40:43], s3 offen lds
    s_add_u32 s57, s57, 229376
    s_cmp_eq_u32 s57, 1605632
    s_cselect_b32 s57, 0, s57
    s_add_u32 m0, s49, 40960
    s_add_u32 s3, s57, 0
    buffer_load_dwordx4 v6, s[40:43], s3 offen lds
    s_add_u32 m0, s49, 41984
    s_add_u32 s3, s57, 28672
    buffer_load_dwordx4 v6, s[40:43], s3 offen lds
    s_add_u32 s57, s57, 229376
    s_cmp_eq_u32 s57, 1605632
    s_cselect_b32 s57, 0, s57
    s_add_u32 m0, s49, 49152
    s_add_u32 s3, s57, 0
    buffer_load_dwordx4 v6, s[40:43], s3 offen lds
    s_add_u32 m0, s49, 50176
    s_add_u32 s3, s57, 28672
    buffer_load_dwordx4 v6, s[40:43], s3 offen lds
    s_add_u32 s57, s57, 229376
    s_cmp_eq_u32 s57, 1605632
    s_cselect_b32 s57, 0, s57
    s_lshl_b32 s3, s52, 6
    s_sub_u32 s26, 0, s49
    v_add_u32 v2, s26, v2
    v_xor_b32 v2, s3, v2
    v_xor_b32 v3, 64, v2
    v_add_u32 v4, 57344, v2
    v_add_u32 v5, 57344, v3
    s_lshr_b32 s3, s56, 1
    s_lshl_b32 s3, s3, 10
    s_add_u32 s3, s3, 22380544
    v_lshl_add_u32 v11, v1, 7, s3
    s_lshl_b32 s26, s55, 1
    s_lshr_b32 s3, s46, 1
    s_add_u32 s26, s26, s3
    v_add_u32 v8, -7, v1
    v_mul_u32_u24 v8, 28, v8
    v_add_u32 v8, s26, v8
    v_and_b32 v9, 1, v8
    v_lshrrev_b32 v10, 5, v8
    v_lshl_add_u32 v9, v9, 3, v10
    v_bfe_u32 v10, v8, 1, 2
    v_lshl_add_u32 v9, v9, 2, v10
    v_bfe_u32 v10, v8, 3, 2
    v_lshl_add_u32 v9, v9, 2, v10
    v_lshlrev_b32 v9, 7, v9
    v_add_u32 v9, 22347776, v9
    v_cmp_gt_u32 vcc, 7, v1
    s_nop 1
    v_cndmask_b32 v11, v9, v11, vcc
    s_mul_i32 s57, s26, 7168
    s_and_b32 s3, s46, 1
    s_lshl_b32 s3, s3, 7
    s_add_u32 s57, s57, s3
    s_add_u32 s57, s57, 8388608
    v_lshrrev_b32 v10, 5, v1
    v_mul_u32_u24 v10, 3584, v10
    v_and_b32 v9, 31, v1
    v_lshl_add_u32 v6, v9, 2, v10
    s_mul_i32 s3, s56, 28672
    s_add_u32 s3, s3, 10485760
    v_add_u32 v7, s3, v0
    s_mul_i32 s51, s45, 4096
    v_lshrrev_b32 v12, 5, v1
    v_mul_u32_u24 v12, 1792, v12
    v_and_b32 v13, 31, v1
    v_lshl_add_u32 v12, v13, 3, v12
    s_mul_i32 s27, s56, 3584
    s_add_u32 s27, s27, 22085632
    s_waitcnt vmcnt(0)
    s_waitcnt lgkmcnt(0)
    s_mov_b64 exec, 1
    v_mov_b32 v8, 159744
    v_mov_b32 v9, 1
    ds_add_u32 v8, v9
    s_mov_b64 exec, -1
    s_mov_b32 s58, 524288
    v_mov_b32 v8, 159744
GL_29:
    ds_read_b32 v9, v8
    s_sub_u32 s58, s58, 1
    s_cbranch_scc1 GD_30
    s_waitcnt lgkmcnt(0)
    v_readfirstlane_b32 s3, v9
    s_nop 1
    s_cmp_lt_u32 s3, 12
    s_cbranch_scc1 GL_29
GD_30:
    s_waitcnt lgkmcnt(0)
    s_mov_b32 s58, 65536
    s_bfm_b64 exec, 14, 0
PL_31:
    buffer_load_dword v9, v11, s[36:39], 0 offen sc1
    s_waitcnt vmcnt(0)
    v_cmp_eq_u32 vcc, 0, v9
    s_nop 1
    s_cbranch_vccz PD_32
    s_sleep 1
    s_sub_u32 s58, s58, 1
    s_cmp_lg_u32 s58, 0
    s_cbranch_scc1 PL_31
PD_32:
    s_mov_b64 exec, -1
    buffer_load_dwordx4 v[112:115], v7, s[36:39], s51 offen offset:0 sc1
    buffer_load_dwordx4 v[116:119], v7, s[36:39], s51 offen offset:1024 sc1
    buffer_load_dwordx4 v[120:123], v7, s[36:39], s51 offen offset:2048 sc1
    buffer_load_dwordx4 v[124:127], v7, s[36:39], s51 offen offset:3072 sc1
    s_add_u32 s51, s51, 4096
    s_cmp_eq_u32 s51, 28672
    s_cselect_b32 s51, 0, s51
    buffer_load_dwordx2 v[104:105], v12, s[36:39], s27 offen offset:0 sc1
    buffer_load_dwordx2 v[106:107], v12, s[36:39], s27 offen offset:256 sc1
    buffer_load_dwordx2 v[108:109], v12, s[36:39], s27 offen offset:512 sc1
    buffer_load_dwordx2 v[110:111], v12, s[36:39], s27 offen offset:768 sc1
    buffer_load_dwordx2 v[248:249], v12, s[36:39], s27 offen offset:1024 sc1
    buffer_load_dwordx2 v[250:251], v12, s[36:39], s27 offen offset:1280 sc1
    buffer_load_dwordx2 v[14:15], v12, s[36:39], s27 offen offset:1536 sc1
    buffer_load_dword v64, v6, s[36:39], s57 offen offset:0 sc1
    buffer_load_dword v65, v6, s[36:39], s57 offen offset:256 sc1
    buffer_load_dword v66, v6, s[36:39], s57 offen offset:512 sc1
    buffer_load_dword v67, v6, s[36:39], s57 offen offset:768 sc1
    buffer_load_dword v68, v6, s[36:39], s57 offen offset:1024 sc1
    buffer_load_dword v69, v6, s[36:39], s57 offen offset:1280 sc1
    buffer_load_dword v70, v6, s[36:39], s57 offen offset:1536 sc1
    buffer_load_dword v71, v6, s[36:39], s57 offen offset:1792 sc1
    buffer_load_dword v72, v6, s[36:39], s57 offen offset:2048 sc1
    buffer_load_dword v73, v6, s[36:39], s57 offen offset:2304 sc1
    buffer_load_dword v74, v6, s[36:39], s57 offen offset:2560 sc1
    buffer_load_dword v75, v6, s[36:39], s57 offen offset:2816 sc1
    buffer_load_dword v76, v6, s[36:39], s57 offen offset:3072 sc1
    buffer_load_dword v77, v6, s[36:39], s57 offen offset:3328 sc1
    buffer_load_dwordx4 v[128:131], v7, s[36:39], s51 offen offset:0 sc1
    buffer_load_dwordx4 v[132:135], v7, s[36:39], s51 offen offset:1024 sc1
    buffer_load_dwordx4 v[136:139], v7, s[36:39], s51 offen offset:2048 sc1
    buffer_load_dwordx4 v[140:143], v7, s[36:39], s51 offen offset:3072 sc1
    s_add_u32 s51, s51, 4096
    s_cmp_eq_u32 s51, 28672
    s_cselect_b32 s51, 0, s51
    s_setprio 1
    ds_read_b64_tr_b16 v[80:81], v2 offset:0
    ds_read_b64_tr_b16 v[82:83], v2 offset:1024
    ds_read_b64_tr_b16 v[84:85], v3 offset:0
    ds_read_b64_tr_b16 v[86:87], v3 offset:1024
    ds_read_b64_tr_b16 v[88:89], v2 offset:2048
    ds_read_b64_tr_b16 v[90:91], v2 offset:3072
    ds_read_b64_tr_b16 v[92:93], v3 offset:2048
    ds_read_b64_tr_b16 v[94:95], v3 offset:3072
    ds_read_b64_tr_b16 v[96:97], v2 offset:4096
    ds_read_b64_tr_b16 v[98:99], v2 offset:5120
    s_waitcnt vmcnt(28)
    s_waitcnt lgkmcnt(6)
    v_mfma_f32_32x32x16_bf16 v[16:31], v[80:83], v[112:115], 0
    ds_read_b64_tr_b16 v[100:101], v3 offset:4096
    ds_read_b64_tr_b16 v[102:103], v3 offset:5120
    v_mfma_f32_32x32x16_bf16 v[32:47], v[84:87], v[112:115], 0
    ds_read_b64_tr_b16 v[80:81], v2 offset:6144
    ds_read_b64_tr_b16 v[82:83], v2 offset:7168
    buffer_load_dwordx4 v[144:147], v7, s[36:39], s51 offen offset:0 sc1
    buffer_load_dwordx4 v[148:151], v7, s[36:39], s51 offen offset:1024 sc1
    s_waitcnt vmcnt(29)
    s_waitcnt lgkmcnt(6)
    v_mfma_f32_32x32x16_bf16 v[16:31], v[88:91], v[116:119], v[16:31]
    ds_read_b64_tr_b16 v[84:85], v3 offset:6144
    ds_read_b64_tr_b16 v[86:87], v3 offset:7168
    v_mfma_f32_32x32x16_bf16 v[32:47], v[92:95], v[116:119], v[32:47]
    ds_read_b64_tr_b16 v[88:89], v2 offset:8192
    ds_read_b64_tr_b16 v[90:91], v2 offset:9216
    buffer_load_dwordx4 v[152:155], v7, s[36:39], s51 offen offset:2048 sc1
    buffer_load_dwordx4 v[156:159], v7, s[36:39], s51 offen offset:3072 sc1
    s_add_u32 s51, s51, 4096
    s_cmp_eq_u32 s51, 28672
    s_cselect_b32 s51, 0, s51
    s_waitcnt vmcnt(30)
    s_waitcnt lgkmcnt(6)
    v_mfma_f32_32x32x16_bf16 v[16:31], v[96:99], v[120:123], v[16:31]
    ds_read_b64_tr_b16 v[92:93], v3 offset:8192
    ds_read_b64_tr_b16 v[94:95], v3 offset:9216
    v_mfma_f32_32x32x16_bf16 v[32:47], v[100:103], v[120:123], v[32:47]
    ds_read_b64_tr_b16 v[96:97], v2 offset:10240
    ds_read_b64_tr_b16 v[98:99], v2 offset:11264
    buffer_load_dwordx4 v[160:163], v7, s[36:39], s51 offen offset:0 sc1
    buffer_load_dwordx4 v[164:167], v7, s[36:39], s51 offen offset:1024 sc1
    s_waitcnt vmcnt(31)
    s_waitcnt lgkmcnt(6)
    v_mfma_f32_32x32x16_bf16 v[16:31], v[80:83], v[124:127], v[16:31]
    ds_read_b64_tr_b16 v[100:101], v3 offset:10240
    ds_read_b64_tr_b16 v[102:103], v3 offset:11264
    v_mfma_f32_32x32x16_bf16 v[32:47], v[84:87], v[124:127], v[32:47]
    ds_read_b64_tr_b16 v[80:81], v2 offset:12288
    ds_read_b64_tr_b16 v[82:83], v2 offset:13312
    buffer_load_dwordx4 v[168:171], v7, s[36:39], s51 offen offset:2048 sc1
    buffer_load_dwordx4 v[172:175], v7, s[36:39], s51 offen offset:3072 sc1
    s_add_u32 s51, s51, 4096
    s_cmp_eq_u32 s51, 28672
    s_cselect_b32 s51, 0, s51
    s_waitcnt vmcnt(11)
    s_waitcnt lgkmcnt(6)
    v_mfma_f32_32x32x16_bf16 v[16:31], v[88:91], v[128:131], v[16:31]
    ds_read_b64_tr_b16 v[84:85], v3 offset:12288
    ds_read_b64_tr_b16 v[86:87], v3 offset:13312
    v_mfma_f32_32x32x16_bf16 v[32:47], v[92:95], v[128:131], v[32:47]
    ds_read_b64_tr_b16 v[88:89], v2 offset:14336
    ds_read_b64_tr_b16 v[90:91], v2 offset:15360
    buffer_load_dwordx4 v[176:179], v7, s[36:39], s51 offen offset:0 sc1
    buffer_load_dwordx4 v[180:183], v7, s[36:39], s51 offen offset:1024 sc1
    v_add_f32 v104, v104, v106
    v_add_f32 v105, v105, v107
    s_waitcnt vmcnt(12)
    s_waitcnt lgkmcnt(6)
    v_mfma_f32_32x32x16_bf16 v[16:31], v[96:99], v[132:135], v[16:31]
    ds_read_b64_tr_b16 v[92:93], v3 offset:14336
    ds_read_b64_tr_b16 v[94:95], v3 offset:15360
    v_add_f32 v104, v104, v108
    v_add_f32 v105, v105, v109
    v_mfma_f32_32x32x16_bf16 v[32:47], v[100:103], v[132:135], v[32:47]
    ds_read_b64_tr_b16 v[96:97], v2 offset:16384
    ds_read_b64_tr_b16 v[98:99], v2 offset:17408
    buffer_load_dwordx4 v[184:187], v7, s[36:39], s51 offen offset:2048 sc1
    buffer_load_dwordx4 v[188:191], v7, s[36:39], s51 offen offset:3072 sc1
    s_add_u32 s51, s51, 4096
    s_cmp_eq_u32 s51, 28672
    s_cselect_b32 s51, 0, s51
    v_add_f32 v104, v104, v110
    v_add_f32 v105, v105, v111
    s_waitcnt vmcnt(13)
    s_waitcnt lgkmcnt(6)
    v_mfma_f32_32x32x16_bf16 v[16:31], v[80:83], v[136:139], v[16:31]
    ds_read_b64_tr_b16 v[100:101], v3 offset:16384
    ds_read_b64_tr_b16 v[102:103], v3 offset:17408
    v_add_f32 v104, v104, v248
    v_add_f32 v105, v105, v249
    v_mfma_f32_32x32x16_bf16 v[32:47], v[84:87], v[136:139], v[32:47]
    ds_read_b64_tr_b16 v[80:81], v2 offset:18432
    ds_read_b64_tr_b16 v[82:83], v2 offset:19456
    buffer_load_dwordx4 v[192:195], v7, s[36:39], s51 offen offset:0 sc1
    v_add_f32 v104, v104, v250
    v_add_f32 v105, v105, v251
    s_waitcnt vmcnt(13)
    s_waitcnt lgkmcnt(6)
    v_mfma_f32_32x32x16_bf16 v[16:31], v[88:91], v[140:143], v[16:31]
    ds_read_b64_tr_b16 v[84:85], v3 offset:18432
    ds_read_b64_tr_b16 v[86:87], v3 offset:19456
    v_add_f32 v104, v104, v14
    v_add_f32 v105, v105, v15
    v_mfma_f32_32x32x16_bf16 v[32:47], v[92:95], v[140:143], v[32:47]
    ds_read_b64_tr_b16 v[88:89], v2 offset:20480
    ds_read_b64_tr_b16 v[90:91], v2 offset:21504
    buffer_load_dwordx4 v[196:199], v7, s[36:39], s51 offen offset:1024 sc1
    v_mov_b32 v12, v104
    v_mov_b32 v13, v105
    s_waitcnt vmcnt(13)
    s_waitcnt lgkmcnt(6)
    v_mfma_f32_32x32x16_bf16 v[16:31], v[96:99], v[144:147], v[16:31]
    ds_read_b64_tr_b16 v[92:93], v3 offset:20480
    ds_read_b64_tr_b16 v[94:95], v3 offset:21504
    v_mov_b32 v8, v12
    s_nop 1
    v_permlane32_swap_b32 v12, v8
    v_mfma_f32_32x32x16_bf16 v[32:47], v[100:103], v[144:147], v[32:47]
    ds_read_b64_tr_b16 v[96:97], v2 offset:22528
    ds_read_b64_tr_b16 v[98:99], v2 offset:23552
    buffer_load_dwordx4 v[200:203], v7, s[36:39], s51 offen offset:2048 sc1
    v_add_f32 v12, v12, v8
    v_mov_b32 v9, v13
    s_waitcnt vmcnt(13)
    s_waitcnt lgkmcnt(6)
    v_mfma_f32_32x32x16_bf16 v[16:31], v[80:83], v[148:151], v[16:31]
    ds_read_b64_tr_b16 v[100:101], v3 offset:22528
    ds_read_b64_tr_b16 v[102:103], v3 offset:23552
    v_permlane32_swap_b32 v13, v9
    v_add_f32 v13, v13, v9
    v_mfma_f32_32x32x16_bf16 v[32:47], v[84:87], v[148:151], v[32:47]
    ds_read_b64_tr_b16 v[80:81], v2 offset:24576
    ds_read_b64_tr_b16 v[82:83], v2 offset:25600
    buffer_load_dwordx4 v[204:207], v7, s[36:39], s51 offen offset:3072 sc1
    s_add_u32 s51, s51, 4096
    s_cmp_eq_u32 s51, 28672
    s_cselect_b32 s51, 0, s51
    v_mul_f32 v12, 0x3b124925, v12
    v_mul_f32 v13, 0x3b124925, v13
    s_waitcnt vmcnt(13)
    s_waitcnt lgkmcnt(6)
    v_mfma_f32_32x32x16_bf16 v[16:31], v[88:91], v[152:155], v[16:31]
    ds_read_b64_tr_b16 v[84:85], v3 offset:24576
    ds_read_b64_tr_b16 v[86:87], v3 offset:25600
    v_fma_f32 v13, -v12, v12, v13
    v_max_f32 v13, 0, v13
    v_mfma_f32_32x32x16_bf16 v[32:47], v[92:95], v[152:155], v[32:47]
    ds_read_b64_tr_b16 v[88:89], v2 offset:26624
    ds_read_b64_tr_b16 v[90:91], v2 offset:27648
    buffer_load_dwordx4 v[208:211], v7, s[36:39], s51 offen offset:0 sc1
    v_add_f32 v13, 0x3727c5ac, v13
    v_sqrt_f32 v247, v13
    s_waitcnt vmcnt(13)
    s_waitcnt lgkmcnt(6)
    v_mfma_f32_32x32x16_bf16 v[16:31], v[96:99], v[156:159], v[16:31]
    ds_read_b64_tr_b16 v[92:93], v3 offset:26624
    ds_read_b64_tr_b16 v[94:95], v3 offset:27648
    v_rsq_f32 v246, v13
    v_cvt_pk_bf16_f32 v244, -v12, -v12
    v_mfma_f32_32x32x16_bf16 v[32:47], v[100:103], v[156:159], v[32:47]
    ds_read_b64_tr_b16 v[96:97], v2 offset:28672
    ds_read_b64_tr_b16 v[98:99], v2 offset:29696
    buffer_load_dwordx4 v[212:215], v7, s[36:39], s51 offen offset:1024 sc1
    v_and_b32 v8, 0xffff0000, v244
    v_sub_f32 v8, -v12, v8
    s_waitcnt vmcnt(13)
    s_waitcnt lgkmcnt(6)
    v_mfma_f32_32x32x16_bf16 v[16:31], v[80:83], v[160:163], v[16:31]
    ds_read_b64_tr_b16 v[100:101], v3 offset:28672
    ds_read_b64_tr_b16 v[102:103], v3 offset:29696
    v_cvt_pk_bf16_f32 v245, v8, 0
    v_and_b32 v245, -1, v245
    v_mfma_f32_32x32x16_bf16 v[32:47], v[84:87], v[160:163], v[32:47]
    ds_read_b64_tr_b16 v[80:81], v2 offset:30720
    ds_read_b64_tr_b16 v[82:83], v2 offset:31744
    buffer_load_dwordx4 v[216:219], v7, s[36:39], s51 offen offset:2048 sc1
    v_lshrrev_b32 v8, 5, v1
    v_add_u32 v8, -1, v8
    s_waitcnt vmcnt(13)
    s_waitcnt lgkmcnt(6)
    v_mfma_f32_32x32x16_bf16 v[16:31], v[88:91], v[164:167], v[16:31]
    ds_read_b64_tr_b16 v[84:85], v3 offset:30720
    ds_read_b64_tr_b16 v[86:87], v3 offset:31744
    v_and_b32 v244, v8, v244
    v_and_b32 v245, v8, v245
    v_mfma_f32_32x32x16_bf16 v[32:47], v[92:95], v[164:167], v[32:47]
    ds_read_b64_tr_b16 v[88:89], v2 offset:32768
    ds_read_b64_tr_b16 v[90:91], v2 offset:33792
    buffer_load_dwordx4 v[220:223], v7, s[36:39], s51 offen offset:3072 sc1
    v_mul_f32 v10, 0xc0135761, v246
    v_mul_f32 v12, v246, v246
    s_waitcnt vmcnt(13)
    s_waitcnt lgkmcnt(6)
    v_mfma_f32_32x32x16_bf16 v[16:31], v[96:99], v[168:171], v[16:31]
    ds_read_b64_tr_b16 v[92:93], v3 offset:32768
    ds_read_b64_tr_b16 v[94:95], v3 offset:33792
    v_mul_f32 v12, v12, v246
    v_mul_f32 v12, 0xbdd2d3e8, v12
    v_mfma_f32_32x32x16_bf16 v[32:47], v[100:103], v[168:171], v[32:47]
    ds_read_b64_tr_b16 v[96:97], v2 offset:34816
    ds_read_b64_tr_b16 v[98:99], v2 offset:35840
    v_mov_b32 v14, v247
    s_mul_i32 s50, s56, 112
    s_waitcnt vmcnt(12)
    s_waitcnt lgkmcnt(6)
    v_mfma_f32_32x32x16_bf16 v[16:31], v[80:83], v[172:175], v[16:31]
    ds_read_b64_tr_b16 v[100:101], v3 offset:34816
    ds_read_b64_tr_b16 v[102:103], v3 offset:35840
    s_lshl_b32 s27, s55, 3
    s_add_u32 s50, s50, s27
    v_mfma_f32_32x32x16_bf16 v[32:47], v[84:87], v[172:175], v[32:47]
    ds_read_b64_tr_b16 v[80:81], v2 offset:36864
    ds_read_b64_tr_b16 v[82:83], v2 offset:37888
    s_lshl_b32 s50, s50, 10
    s_add_u32 s50, s50, 14680064
    s_waitcnt vmcnt(11)
    s_waitcnt lgkmcnt(6)
    v_mfma_f32_32x32x16_bf16 v[16:31], v[88:91], v[176:179], v[16:31]
    ds_read_b64_tr_b16 v[84:85], v3 offset:36864
    ds_read_b64_tr_b16 v[86:87], v3 offset:37888
    s_add_u32 s27, s50, 4096
    v_add_f32 v64, v64, v65
    v_mfma_f32_32x32x16_bf16 v[32:47], v[92:95], v[176:179], v[32:47]
    ds_read_b64_tr_b16 v[88:89], v2 offset:38912
    ds_read_b64_tr_b16 v[90:91], v2 offset:39936
    v_add_f32 v64, v64, v66
    v_add_f32 v64, v64, v67
    s_waitcnt vmcnt(10)
    s_waitcnt lgkmcnt(6)
    v_mfma_f32_32x32x16_bf16 v[16:31], v[96:99], v[180:183], v[16:31]
    ds_read_b64_tr_b16 v[92:93], v3 offset:38912
    ds_read_b64_tr_b16 v[94:95], v3 offset:39936
    v_add_f32 v64, v64, v68
    v_add_f32 v64, v64, v69
    v_mfma_f32_32x32x16_bf16 v[32:47], v[100:103], v[180:183], v[32:47]
    ds_read_b64_tr_b16 v[96:97], v2 offset:40960
    ds_read_b64_tr_b16 v[98:99], v2 offset:41984
    v_add_f32 v64, v64, v70
    v_add_f32 v64, v64, v71
    s_waitcnt vmcnt(9)
    s_waitcnt lgkmcnt(6)
    v_mfma_f32_32x32x16_bf16 v[16:31], v[80:83], v[184:187], v[16:31]
    ds_read_b64_tr_b16 v[100:101], v3 offset:40960
    ds_read_b64_tr_b16 v[102:103], v3 offset:41984
    v_add_f32 v64, v64, v72
    v_add_f32 v64, v64, v73
    v_mfma_f32_32x32x16_bf16 v[32:47], v[84:87], v[184:187], v[32:47]
    ds_read_b64_tr_b16 v[80:81], v2 offset:43008
    ds_read_b64_tr_b16 v[82:83], v2 offset:44032
    v_add_f32 v64, v64, v74
    v_add_f32 v64, v64, v75
    s_waitcnt vmcnt(8)
    s_waitcnt lgkmcnt(6)
    v_mfma_f32_32x32x16_bf16 v[16:31], v[88:91], v[188:191], v[16:31]
    ds_read_b64_tr_b16 v[84:85], v3 offset:43008
    ds_read_b64_tr_b16 v[86:87], v3 offset:44032
    v_add_f32 v64, v64, v76
    v_add_f32 v64, v64, v77
    v_mfma_f32_32x32x16_bf16 v[32:47], v[92:95], v[188:191], v[32:47]
    ds_read_b64_tr_b16 v[88:89], v2 offset:45056
    ds_read_b64_tr_b16 v[90:91], v2 offset:46080
    v_mov_b32 v8, v64
    s_nop 1
    v_permlane32_swap_b32 v64, v8
    s_waitcnt vmcnt(7)
    s_waitcnt lgkmcnt(6)
    v_mfma_f32_32x32x16_bf16 v[16:31], v[96:99], v[192:195], v[16:31]
    ds_read_b64_tr_b16 v[92:93], v3 offset:45056
    ds_read_b64_tr_b16 v[94:95], v3 offset:46080
    v_add_f32 v64, v64, v8
    v_cvt_pk_bf16_f32 v11, v64, v64
    v_mfma_f32_32x32x16_bf16 v[32:47], v[100:103], v[192:195], v[32:47]
    ds_read_b64_tr_b16 v[96:97], v2 offset:47104
    ds_read_b64_tr_b16 v[98:99], v2 offset:48128
    v_and_b32 v11, 0xffff0000, v11
    v_sub_f32 v11, v64, v11
    s_waitcnt vmcnt(6)
    s_waitcnt lgkmcnt(6)
    v_mfma_f32_32x32x16_bf16 v[16:31], v[80:83], v[196:199], v[16:31]
    ds_read_b64_tr_b16 v[100:101], v3 offset:47104
    ds_read_b64_tr_b16 v[102:103], v3 offset:48128
    v_cvt_pk_bf16_f32 v11, v64, v11
    s_lshl_b32 s26, s46, 7
    v_mfma_f32_32x32x16_bf16 v[32:47], v[84:87], v[196:199], v[32:47]
    ds_read_b64_tr_b16 v[80:81], v2 offset:49152
    ds_read_b64_tr_b16 v[82:83], v2 offset:50176
    s_add_u32 s26, s26, 160768
    v_and_b32 v13, 31, v1
    s_waitcnt vmcnt(5)
    s_waitcnt lgkmcnt(6)
    v_mfma_f32_32x32x16_bf16 v[16:31], v[88:91], v[200:203], v[16:31]
    ds_read_b64_tr_b16 v[84:85], v3 offset:49152
    ds_read_b64_tr_b16 v[86:87], v3 offset:50176
    v_lshl_add_u32 v13, v13, 2, s26
    v_mfma_f32_32x32x16_bf16 v[32:47], v[92:95], v[200:203], v[32:47]
    ds_read_b64_tr_b16 v[88:89], v2 offset:51200
    ds_read_b64_tr_b16 v[90:91], v2 offset:52224
    s_waitcnt vmcnt(4)
    s_waitcnt lgkmcnt(6)
    v_mfma_f32_32x32x16_bf16 v[16:31], v[96:99], v[204:207], v[16:31]
    ds_read_b64_tr_b16 v[92:93], v3 offset:51200
    ds_read_b64_tr_b16 v[94:95], v3 offset:52224
    v_mfma_f32_32x32x16_bf16 v[32:47], v[100:103], v[204:207], v[32:47]
    ds_read_b64_tr_b16 v[96:97], v2 offset:53248
    ds_read_b64_tr_b16 v[98:99], v2 offset:54272
    s_waitcnt vmcnt(3)
    s_waitcnt lgkmcnt(6)
    v_mfma_f32_32x32x16_bf16 v[16:31], v[80:83], v[208:211], v[16:31]
    ds_read_b64_tr_b16 v[100:101], v3 offset:53248
    ds_read_b64_tr_b16 v[102:103], v3 offset:54272
    v_mfma_f32_32x32x16_bf16 v[32:47], v[84:87], v[208:211], v[32:47]
    ds_read_b64_tr_b16 v[80:81], v2 offset:55296
    ds_read_b64_tr_b16 v[82:83], v2 offset:56320
    s_waitcnt vmcnt(2)
    s_waitcnt lgkmcnt(6)
    v_mfma_f32_32x32x16_bf16 v[16:31], v[88:91], v[212:215], v[16:31]
    ds_read_b64_tr_b16 v[84:85], v3 offset:55296
    ds_read_b64_tr_b16 v[86:87], v3 offset:56320
    v_mfma_f32_32x32x16_bf16 v[32:47], v[92:95], v[212:215], v[32:47]
    s_waitcnt vmcnt(1)
    s_waitcnt lgkmcnt(4)
    v_mfma_f32_32x32x16_bf16 v[16:31], v[96:99], v[216:219], v[16:31]
    v_mfma_f32_32x32x16_bf16 v[32:47], v[100:103], v[216:219], v[32:47]
    ds_write_b32 v13, v11
    s_mov_b64 exec, 1
    v_mov_b32 v8, 159744
    v_mov_b32 v9, 1
    ds_add_u32 v8, v9
    s_mov_b64 exec, -1
    s_waitcnt vmcnt(0)
    s_waitcnt lgkmcnt(0)
    v_mfma_f32_32x32x16_bf16 v[16:31], v[80:83], v[220:223], v[16:31]
    v_mfma_f32_32x32x16_bf16 v[32:47], v[84:87], v[220:223], v[32:47]
    s_setprio 1
    s_mov_b32 s58, 524288
    v_mov_b32 v8, 159744
GL_33:
    ds_read_b32 v9, v8
    s_sub_u32 s58, s58, 1
    s_cbranch_scc1 GD_34
    s_waitcnt lgkmcnt(0)
    v_readfirstlane_b32 s3, v9
    s_nop 1
    s_cmp_lt_u32 s3, 16
    s_cbranch_scc1 GL_33
GD_34:
    s_waitcnt lgkmcnt(0)
    v_and_b32 v15, 31, v1
    v_lshlrev_b32 v15, 2, v15
    v_add_u32 v15, 160768, v15
    ds_read_b32 v240, v15 offset:0
    ds_read_b32 v241, v15 offset:128
    ds_read_b32 v242, v15 offset:256
    ds_read_b32 v243, v15 offset:384
    s_waitcnt lgkmcnt(0)
    s_mov_b64 exec, 1
    v_mov_b32 v8, 159744
    v_mov_b32 v9, 1
    ds_add_u32 v8, v9
    s_mov_b64 exec, -1
    v_mov_b32 v88, v244
    v_mov_b32 v89, v245
    v_mov_b32 v90, 0
    v_mov_b32 v91, 0
    v_mov_b32 v80, v240
    v_and_b32 v81, 0xffff, v240
    v_mov_b32 v82, 0
    v_mov_b32 v83, 0
    v_mov_b32 v84, v241
    v_and_b32 v85, 0xffff, v241
    v_mov_b32 v86, 0
    v_mov_b32 v87, 0
    v_mfma_f32_32x32x16_bf16 v[16:31], v[80:83], v[88:91], v[16:31]
    s_nop 0
    v_mfma_f32_32x32x16_bf16 v[32:47], v[84:87], v[88:91], v[32:47]
    s_mov_b32 s32, s18
    s_mov_b32 s33, s19
    s_mov_b32 s34, 1605632
    s_mov_b32 s35, 0x20000
    v_lshrrev_b32 v8, 3, v1
    v_bfe_u32 v9, v1, 4, 1
    v_lshlrev_b32 v9, 2, v9
    v_and_b32 v7, 7, v1
    v_xor_b32 v9, v9, v7
    v_mul_u32_u24 v8, 896, v8
    v_lshl_add_u32 v7, v9, 4, v8
    s_and_b32 s3, s2, 1
    s_mul_i32 s3, s3, 56
    s_add_u32 s3, s3, s46
    s_mul_i32 s3, s3, 14336
    s_lshl_b32 s26, s45, 7
    s_add_u32 s3, s3, s26
    v_add_u32 v7, s3, v7
    s_mul_i32 s57, s45, 114688
    ds_read_b64_tr_b16 v[80:81], v4 offset:0
    ds_read_b64_tr_b16 v[82:83], v4 offset:1024
    ds_read_b64_tr_b16 v[84:85], v5 offset:0
    ds_read_b64_tr_b16 v[86:87], v5 offset:1024
    ds_read_b64_tr_b16 v[88:89], v4 offset:2048
    ds_read_b64_tr_b16 v[90:91], v4 offset:3072
    ds_read_b64_tr_b16 v[92:93], v5 offset:2048
    ds_read_b64_tr_b16 v[94:95], v5 offset:3072
    ds_read_b64_tr_b16 v[96:97], v4 offset:4096
    ds_read_b64_tr_b16 v[98:99], v4 offset:5120
    s_waitcnt lgkmcnt(6)
    v_mfma_f32_32x32x16_bf16 v[48:63], v[80:83], v[112:115], 0
    ds_read_b64_tr_b16 v[100:101], v5 offset:4096
    ds_read_b64_tr_b16 v[102:103], v5 offset:5120
    v_mfma_f32_32x32x16_bf16 v[64:79], v[84:87], v[112:115], 0
    ds_read_b64_tr_b16 v[80:81], v4 offset:6144
    ds_read_b64_tr_b16 v[82:83], v4 offset:7168
    v_mul_f32 v248, v16, v16
    v_mul_f32 v249, v17, v17
    v_mul_f32 v250, v18, v18
    v_mul_f32 v251, v19, v19
    v_mul_f32 v252, v20, v20
    s_waitcnt lgkmcnt(6)
    v_mfma_f32_32x32x16_bf16 v[48:63], v[88:91], v[116:119], v[48:63]
    ds_read_b64_tr_b16 v[84:85], v5 offset:6144
    ds_read_b64_tr_b16 v[86:87], v5 offset:7168
    v_mul_f32 v253, v21, v21
    v_mul_f32 v254, v22, v22
    v_mul_f32 v255, v23, v23
    v_fma_f32 v248, v248, v12, v10
    v_fma_f32 v249, v249, v12, v10
    v_mfma_f32_32x32x16_bf16 v[64:79], v[92:95], v[116:119], v[64:79]
    ds_read_b64_tr_b16 v[88:89], v4 offset:8192
    ds_read_b64_tr_b16 v[90:91], v4 offset:9216
    v_fma_f32 v250, v250, v12, v10
    v_fma_f32 v251, v251, v12, v10
    v_fma_f32 v252, v252, v12, v10
    v_fma_f32 v253, v253, v12, v10
    v_fma_f32 v254, v254, v12, v10
    s_waitcnt lgkmcnt(6)
    v_mfma_f32_32x32x16_bf16 v[48:63], v[96:99], v[120:123], v[48:63]
    ds_read_b64_tr_b16 v[92:93], v5 offset:8192
    ds_read_b64_tr_b16 v[94:95], v5 offset:9216
    v_fma_f32 v255, v255, v12, v10
    v_mul_f32 v248, v248, v16
    v_mul_f32 v249, v249, v17
    v_mul_f32 v250, v250, v18
    v_mul_f32 v251, v251, v19
    v_mfma_f32_32x32x16_bf16 v[64:79], v[100:103], v[120:123], v[64:79]
    ds_read_b64_tr_b16 v[96:97], v4 offset:10240
    ds_read_b64_tr_b16 v[98:99], v4 offset:11264
    v_mul_f32 v252, v252, v20
    v_mul_f32 v253, v253, v21
    v_mul_f32 v254, v254, v22
    v_mul_f32 v255, v255, v23
    v_exp_f32 v248, v248
    s_waitcnt lgkmcnt(6)
    v_mfma_f32_32x32x16_bf16 v[48:63], v[80:83], v[124:127], v[48:63]
    ds_read_b64_tr_b16 v[100:101], v5 offset:10240
    ds_read_b64_tr_b16 v[102:103], v5 offset:11264
    v_exp_f32 v249, v249
    v_exp_f32 v250, v250
    v_exp_f32 v251, v251
    v_exp_f32 v252, v252
    v_exp_f32 v253, v253
    v_mfma_f32_32x32x16_bf16 v[64:79], v[84:87], v[124:127], v[64:79]
    ds_read_b64_tr_b16 v[80:81], v4 offset:12288
    ds_read_b64_tr_b16 v[82:83], v4 offset:13312
    v_exp_f32 v254, v254
    v_exp_f32 v255, v255
    v_fma_f32 v248, v248, v14, v14
    v_fma_f32 v249, v249, v14, v14
    v_fma_f32 v250, v250, v14, v14
    s_waitcnt lgkmcnt(6)
    v_mfma_f32_32x32x16_bf16 v[48:63], v[88:91], v[128:131], v[48:63]
    ds_read_b64_tr_b16 v[84:85], v5 offset:12288
    ds_read_b64_tr_b16 v[86:87], v5 offset:13312
    v_fma_f32 v251, v251, v14, v14
    v_fma_f32 v252, v252, v14, v14
    v_fma_f32 v253, v253, v14, v14
    v_fma_f32 v254, v254, v14, v14
    v_fma_f32 v255, v255, v14, v14
    v_mfma_f32_32x32x16_bf16 v[64:79], v[92:95], v[128:131], v[64:79]
    ds_read_b64_tr_b16 v[88:89], v4 offset:14336
    ds_read_b64_tr_b16 v[90:91], v4 offset:15360
    v_rcp_f32 v248, v248
    v_rcp_f32 v249, v249
    v_rcp_f32 v250, v250
    v_rcp_f32 v251, v251
    v_rcp_f32 v252, v252
    s_waitcnt lgkmcnt(6)
    v_mfma_f32_32x32x16_bf16 v[48:63], v[96:99], v[132:135], v[48:63]
    ds_read_b64_tr_b16 v[92:93], v5 offset:14336
    ds_read_b64_tr_b16 v[94:95], v5 offset:15360
    v_rcp_f32 v253, v253
    v_rcp_f32 v254, v254
    v_rcp_f32 v255, v255
    v_mul_f32 v248, v248, v16
    v_mul_f32 v249, v249, v17
    v_mfma_f32_32x32x16_bf16 v[64:79], v[100:103], v[132:135], v[64:79]
    ds_read_b64_tr_b16 v[96:97], v4 offset:16384
    ds_read_b64_tr_b16 v[98:99], v4 offset:17408
    v_mul_f32 v250, v250, v18
    v_mul_f32 v251, v251, v19
    v_mul_f32 v252, v252, v20
    v_mul_f32 v253, v253, v21
    v_mul_f32 v254, v254, v22
    s_waitcnt lgkmcnt(6)
    v_mfma_f32_32x32x16_bf16 v[48:63], v[80:83], v[136:139], v[48:63]
    ds_read_b64_tr_b16 v[100:101], v5 offset:16384
    ds_read_b64_tr_b16 v[102:103], v5 offset:17408
    v_mul_f32 v255, v255, v23
    v_cvt_pk_bf16_f32 v112, v248, v249
    v_cvt_pk_bf16_f32 v113, v250, v251
    v_cvt_pk_bf16_f32 v114, v252, v253
    v_cvt_pk_bf16_f32 v115, v254, v255
    v_mfma_f32_32x32x16_bf16 v[64:79], v[84:87], v[136:139], v[64:79]
    ds_read_b64_tr_b16 v[80:81], v4 offset:18432
    ds_read_b64_tr_b16 v[82:83], v4 offset:19456
    buffer_store_dwordx4 v[112:115], v0, s[36:39], s50 offen offset:0 sc1
    v_mul_f32 v248, v24, v24
    v_mul_f32 v249, v25, v25
    v_mul_f32 v250, v26, v26
    v_mul_f32 v251, v27, v27
    s_waitcnt lgkmcnt(6)
    v_mfma_f32_32x32x16_bf16 v[48:63], v[88:91], v[140:143], v[48:63]
    ds_read_b64_tr_b16 v[84:85], v5 offset:18432
    ds_read_b64_tr_b16 v[86:87], v5 offset:19456
    v_mul_f32 v252, v28, v28
    v_mul_f32 v253, v29, v29
    v_mul_f32 v254, v30, v30
    v_mul_f32 v255, v31, v31
    v_fma_f32 v248, v248, v12, v10
    v_mfma_f32_32x32x16_bf16 v[64:79], v[92:95], v[140:143], v[64:79]
    ds_read_b64_tr_b16 v[88:89], v4 offset:20480
    ds_read_b64_tr_b16 v[90:91], v4 offset:21504
    v_fma_f32 v249, v249, v12, v10
    v_fma_f32 v250, v250, v12, v10
    v_fma_f32 v251, v251, v12, v10
    v_fma_f32 v252, v252, v12, v10
    v_fma_f32 v253, v253, v12, v10
    s_waitcnt lgkmcnt(6)
    v_mfma_f32_32x32x16_bf16 v[48:63], v[96:99], v[144:147], v[48:63]
    ds_read_b64_tr_b16 v[92:93], v5 offset:20480
    ds_read_b64_tr_b16 v[94:95], v5 offset:21504
    v_fma_f32 v254, v254, v12, v10
    v_fma_f32 v255, v255, v12, v10
    v_mul_f32 v248, v248, v24
    v_mul_f32 v249, v249, v25
    v_mul_f32 v250, v250, v26
    v_mfma_f32_32x32x16_bf16 v[64:79], v[100:103], v[144:147], v[64:79]
    ds_read_b64_tr_b16 v[96:97], v4 offset:22528
    ds_read_b64_tr_b16 v[98:99], v4 offset:23552
    v_mul_f32 v251, v251, v27
    v_mul_f32 v252, v252, v28
    v_mul_f32 v253, v253, v29
    v_mul_f32 v254, v254, v30
    v_mul_f32 v255, v255, v31
    s_waitcnt lgkmcnt(6)
    v_mfma_f32_32x32x16_bf16 v[48:63], v[80:83], v[148:151], v[48:63]
    ds_read_b64_tr_b16 v[100:101], v5 offset:22528
    ds_read_b64_tr_b16 v[102:103], v5 offset:23552
    v_exp_f32 v248, v248
    v_exp_f32 v249, v249
    v_exp_f32 v250, v250
    v_exp_f32 v251, v251
    v_exp_f32 v252, v252
    v_mfma_f32_32x32x16_bf16 v[64:79], v[84:87], v[148:151], v[64:79]
    ds_read_b64_tr_b16 v[80:81], v4 offset:24576
    ds_read_b64_tr_b16 v[82:83], v4 offset:25600
    v_exp_f32 v253, v253
    v_exp_f32 v254, v254
    v_exp_f32 v255, v255
    v_fma_f32 v248, v248, v14, v14
    v_fma_f32 v249, v249, v14, v14
    s_waitcnt lgkmcnt(6)
    v_mfma_f32_32x32x16_bf16 v[48:63], v[88:91], v[152:155], v[48:63]
    ds_read_b64_tr_b16 v[84:85], v5 offset:24576
    ds_read_b64_tr_b16 v[86:87], v5 offset:25600
    v_fma_f32 v250, v250, v14, v14
    v_fma_f32 v251, v251, v14, v14
    v_fma_f32 v252, v252, v14, v14
    v_fma_f32 v253, v253, v14, v14
    v_fma_f32 v254, v254, v14, v14
    v_mfma_f32_32x32x16_bf16 v[64:79], v[92:95], v[152:155], v[64:79]
    ds_read_b64_tr_b16 v[88:89], v4 offset:26624
    ds_read_b64_tr_b16 v[90:91], v4 offset:27648
    v_fma_f32 v255, v255, v14, v14
    v_rcp_f32 v248, v248
    v_rcp_f32 v249, v249
    v_rcp_f32 v250, v250
    v_rcp_f32 v251, v251
    s_waitcnt lgkmcnt(6)
    v_mfma_f32_32x32x16_bf16 v[48:63], v[96:99], v[156:159], v[48:63]
    ds_read_b64_tr_b16 v[92:93], v5 offset:26624
    ds_read_b64_tr_b16 v[94:95], v5 offset:27648
    v_rcp_f32 v252, v252
    v_rcp_f32 v253, v253
    v_rcp_f32 v254, v254
    v_rcp_f32 v255, v255
    v_mul_f32 v248, v248, v24
    v_mfma_f32_32x32x16_bf16 v[64:79], v[100:103], v[156:159], v[64:79]
    ds_read_b64_tr_b16 v[96:97], v4 offset:28672
    ds_read_b64_tr_b16 v[98:99], v4 offset:29696
    v_mul_f32 v249, v249, v25
    v_mul_f32 v250, v250, v26
    v_mul_f32 v251, v251, v27
    v_mul_f32 v252, v252, v28
    v_mul_f32 v253, v253, v29
    s_waitcnt lgkmcnt(6)
    v_mfma_f32_32x32x16_bf16 v[48:63], v[80:83], v[160:163], v[48:63]
    ds_read_b64_tr_b16 v[100:101], v5 offset:28672
    ds_read_b64_tr_b16 v[102:103], v5 offset:29696
    v_mul_f32 v254, v254, v30
    v_mul_f32 v255, v255, v31
    v_cvt_pk_bf16_f32 v116, v248, v249
    v_cvt_pk_bf16_f32 v117, v250, v251
    v_cvt_pk_bf16_f32 v118, v252, v253
    v_mfma_f32_32x32x16_bf16 v[64:79], v[84:87], v[160:163], v[64:79]
    ds_read_b64_tr_b16 v[80:81], v4 offset:30720
    ds_read_b64_tr_b16 v[82:83], v4 offset:31744
    v_cvt_pk_bf16_f32 v119, v254, v255
    buffer_store_dwordx4 v[116:119], v0, s[36:39], s50 offen offset:1024 sc1
    v_mul_f32 v248, v32, v32
    v_mul_f32 v249, v33, v33
    v_mul_f32 v250, v34, v34
    s_waitcnt lgkmcnt(6)
    v_mfma_f32_32x32x16_bf16 v[48:63], v[88:91], v[164:167], v[48:63]
    ds_read_b64_tr_b16 v[84:85], v5 offset:30720
    ds_read_b64_tr_b16 v[86:87], v5 offset:31744
    v_mul_f32 v251, v35, v35
    v_mul_f32 v252, v36, v36
    v_mul_f32 v253, v37, v37
    v_mul_f32 v254, v38, v38
    v_mul_f32 v255, v39, v39
    v_mfma_f32_32x32x16_bf16 v[64:79], v[92:95], v[164:167], v[64:79]
    ds_read_b64_tr_b16 v[88:89], v4 offset:32768
    ds_read_b64_tr_b16 v[90:91], v4 offset:33792
    v_fma_f32 v248, v248, v12, v10
    v_fma_f32 v249, v249, v12, v10
    v_fma_f32 v250, v250, v12, v10
    v_fma_f32 v251, v251, v12, v10
    v_fma_f32 v252, v252, v12, v10
    s_waitcnt lgkmcnt(6)
    v_mfma_f32_32x32x16_bf16 v[48:63], v[96:99], v[168:171], v[48:63]
    ds_read_b64_tr_b16 v[92:93], v5 offset:32768
    ds_read_b64_tr_b16 v[94:95], v5 offset:33792
    v_fma_f32 v253, v253, v12, v10
    v_fma_f32 v254, v254, v12, v10
    v_fma_f32 v255, v255, v12, v10
    v_mul_f32 v248, v248, v32
    v_mul_f32 v249, v249, v33
    v_mfma_f32_32x32x16_bf16 v[64:79], v[100:103], v[168:171], v[64:79]
    ds_read_b64_tr_b16 v[96:97], v4 offset:34816
    ds_read_b64_tr_b16 v[98:99], v4 offset:35840
    v_mul_f32 v250, v250, v34
    v_mul_f32 v251, v251, v35
    v_mul_f32 v252, v252, v36
    v_mul_f32 v253, v253, v37
    v_mul_f32 v254, v254, v38
    s_waitcnt lgkmcnt(6)
    v_mfma_f32_32x32x16_bf16 v[48:63], v[80:83], v[172:175], v[48:63]
    ds_read_b64_tr_b16 v[100:101], v5 offset:34816
    ds_read_b64_tr_b16 v[102:103], v5 offset:35840
    v_mul_f32 v255, v255, v39
    v_exp_f32 v248, v248
    v_exp_f32 v249, v249
    v_exp_f32 v250, v250
    v_exp_f32 v251, v251
    v_mfma_f32_32x32x16_bf16 v[64:79], v[84:87], v[172:175], v[64:79]
    ds_read_b64_tr_b16 v[80:81], v4 offset:36864
    ds_read_b64_tr_b16 v[82:83], v4 offset:37888
    v_exp_f32 v252, v252
    v_exp_f32 v253, v253
    v_exp_f32 v254, v254
    v_exp_f32 v255, v255
    v_fma_f32 v248, v248, v14, v14
    s_waitcnt lgkmcnt(6)
    v_mfma_f32_32x32x16_bf16 v[48:63], v[88:91], v[176:179], v[48:63]
    ds_read_b64_tr_b16 v[84:85], v5 offset:36864
    ds_read_b64_tr_b16 v[86:87], v5 offset:37888
    v_fma_f32 v249, v249, v14, v14
    v_fma_f32 v250, v250, v14, v14
    v_fma_f32 v251, v251, v14, v14
    v_fma_f32 v252, v252, v14, v14
    v_fma_f32 v253, v253, v14, v14
    v_mfma_f32_32x32x16_bf16 v[64:79], v[92:95], v[176:179], v[64:79]
    ds_read_b64_tr_b16 v[88:89], v4 offset:38912
    ds_read_b64_tr_b16 v[90:91], v4 offset:39936
    v_fma_f32 v254, v254, v14, v14
    v_fma_f32 v255, v255, v14, v14
    v_rcp_f32 v248, v248
    v_rcp_f32 v249, v249
    v_rcp_f32 v250, v250
    s_waitcnt lgkmcnt(6)
    v_mfma_f32_32x32x16_bf16 v[48:63], v[96:99], v[180:183], v[48:63]
    ds_read_b64_tr_b16 v[92:93], v5 offset:38912
    ds_read_b64_tr_b16 v[94:95], v5 offset:39936
    v_rcp_f32 v251, v251
    v_rcp_f32 v252, v252
    v_rcp_f32 v253, v253
    v_rcp_f32 v254, v254
    v_rcp_f32 v255, v255
    v_mfma_f32_32x32x16_bf16 v[64:79], v[100:103], v[180:183], v[64:79]
    ds_read_b64_tr_b16 v[96:97], v4 offset:40960
    ds_read_b64_tr_b16 v[98:99], v4 offset:41984
    v_mul_f32 v248, v248, v32
    v_mul_f32 v249, v249, v33
    v_mul_f32 v250, v250, v34
    v_mul_f32 v251, v251, v35
    v_mul_f32 v252, v252, v36
    s_waitcnt lgkmcnt(6)
    v_mfma_f32_32x32x16_bf16 v[48:63], v[80:83], v[184:187], v[48:63]
    ds_read_b64_tr_b16 v[100:101], v5 offset:40960
    ds_read_b64_tr_b16 v[102:103], v5 offset:41984
    v_mul_f32 v253, v253, v37
    v_mul_f32 v254, v254, v38
    v_mul_f32 v255, v255, v39
    v_cvt_pk_bf16_f32 v120, v248, v249
    v_cvt_pk_bf16_f32 v121, v250, v251
    v_mfma_f32_32x32x16_bf16 v[64:79], v[84:87], v[184:187], v[64:79]
    ds_read_b64_tr_b16 v[80:81], v4 offset:43008
    ds_read_b64_tr_b16 v[82:83], v4 offset:44032
    v_cvt_pk_bf16_f32 v122, v252, v253
    v_cvt_pk_bf16_f32 v123, v254, v255
    buffer_store_dwordx4 v[120:123], v0, s[36:39], s50 offen offset:2048 sc1
    v_mul_f32 v248, v40, v40
    v_mul_f32 v249, v41, v41
    s_waitcnt lgkmcnt(6)
    v_mfma_f32_32x32x16_bf16 v[48:63], v[88:91], v[188:191], v[48:63]
    ds_read_b64_tr_b16 v[84:85], v5 offset:43008
    ds_read_b64_tr_b16 v[86:87], v5 offset:44032
    v_mul_f32 v250, v42, v42
    v_mul_f32 v251, v43, v43
    v_mul_f32 v252, v44, v44
    v_mul_f32 v253, v45, v45
    v_mul_f32 v254, v46, v46
    v_mfma_f32_32x32x16_bf16 v[64:79], v[92:95], v[188:191], v[64:79]
    ds_read_b64_tr_b16 v[88:89], v4 offset:45056
    ds_read_b64_tr_b16 v[90:91], v4 offset:46080
    v_mul_f32 v255, v47, v47
    v_fma_f32 v248, v248, v12, v10
    v_fma_f32 v249, v249, v12, v10
    v_fma_f32 v250, v250, v12, v10
    v_fma_f32 v251, v251, v12, v10
    s_waitcnt lgkmcnt(6)
    v_mfma_f32_32x32x16_bf16 v[48:63], v[96:99], v[192:195], v[48:63]
    ds_read_b64_tr_b16 v[92:93], v5 offset:45056
    ds_read_b64_tr_b16 v[94:95], v5 offset:46080
    v_fma_f32 v252, v252, v12, v10
    v_fma_f32 v253, v253, v12, v10
    v_fma_f32 v254, v254, v12, v10
    v_fma_f32 v255, v255, v12, v10
    v_mul_f32 v248, v248, v40
    v_mfma_f32_32x32x16_bf16 v[64:79], v[100:103], v[192:195], v[64:79]
    ds_read_b64_tr_b16 v[96:97], v4 offset:47104
    ds_read_b64_tr_b16 v[98:99], v4 offset:48128
    v_mul_f32 v249, v249, v41
    v_mul_f32 v250, v250, v42
    v_mul_f32 v251, v251, v43
    v_mul_f32 v252, v252, v44
    v_mul_f32 v253, v253, v45
    s_waitcnt lgkmcnt(6)
    v_mfma_f32_32x32x16_bf16 v[48:63], v[80:83], v[196:199], v[48:63]
    ds_read_b64_tr_b16 v[100:101], v5 offset:47104
    ds_read_b64_tr_b16 v[102:103], v5 offset:48128
    v_mul_f32 v254, v254, v46
    v_mul_f32 v255, v255, v47
    v_exp_f32 v248, v248
    v_exp_f32 v249, v249
    v_exp_f32 v250, v250
    v_mfma_f32_32x32x16_bf16 v[64:79], v[84:87], v[196:199], v[64:79]
    ds_read_b64_tr_b16 v[80:81], v4 offset:49152
    ds_read_b64_tr_b16 v[82:83], v4 offset:50176
    v_exp_f32 v251, v251
    v_exp_f32 v252, v252
    v_exp_f32 v253, v253
    v_exp_f32 v254, v254
    v_exp_f32 v255, v255
    s_waitcnt lgkmcnt(6)
    v_mfma_f32_32x32x16_bf16 v[48:63], v[88:91], v[200:203], v[48:63]
    ds_read_b64_tr_b16 v[84:85], v5 offset:49152
    ds_read_b64_tr_b16 v[86:87], v5 offset:50176
    v_fma_f32 v248, v248, v14, v14
    v_fma_f32 v249, v249, v14, v14
    v_fma_f32 v250, v250, v14, v14
    v_fma_f32 v251, v251, v14, v14
    v_fma_f32 v252, v252, v14, v14
    v_mfma_f32_32x32x16_bf16 v[64:79], v[92:95], v[200:203], v[64:79]
    ds_read_b64_tr_b16 v[88:89], v4 offset:51200
    ds_read_b64_tr_b16 v[90:91], v4 offset:52224
    v_fma_f32 v253, v253, v14, v14
    v_fma_f32 v254, v254, v14, v14
    v_fma_f32 v255, v255, v14, v14
    v_rcp_f32 v248, v248
    v_rcp_f32 v249, v249
    s_waitcnt lgkmcnt(6)
    v_mfma_f32_32x32x16_bf16 v[48:63], v[96:99], v[204:207], v[48:63]
    ds_read_b64_tr_b16 v[92:93], v5 offset:51200
    ds_read_b64_tr_b16 v[94:95], v5 offset:52224
    v_rcp_f32 v250, v250
    v_rcp_f32 v251, v251
    v_rcp_f32 v252, v252
    v_rcp_f32 v253, v253
    v_rcp_f32 v254, v254
    v_mfma_f32_32x32x16_bf16 v[64:79], v[100:103], v[204:207], v[64:79]
    ds_read_b64_tr_b16 v[96:97], v4 offset:53248
    ds_read_b64_tr_b16 v[98:99], v4 offset:54272
    v_rcp_f32 v255, v255
    v_mul_f32 v248, v248, v40
    v_mul_f32 v249, v249, v41
    v_mul_f32 v250, v250, v42
    v_mul_f32 v251, v251, v43
    s_waitcnt lgkmcnt(6)
    v_mfma_f32_32x32x16_bf16 v[48:63], v[80:83], v[208:211], v[48:63]
    ds_read_b64_tr_b16 v[100:101], v5 offset:53248
    ds_read_b64_tr_b16 v[102:103], v5 offset:54272
    v_mul_f32 v252, v252, v44
    v_mul_f32 v253, v253, v45
    v_mul_f32 v254, v254, v46
    v_mul_f32 v255, v255, v47
    v_cvt_pk_bf16_f32 v124, v248, v249
    v_mfma_f32_32x32x16_bf16 v[64:79], v[84:87], v[208:211], v[64:79]
    ds_read_b64_tr_b16 v[80:81], v4 offset:55296
    ds_read_b64_tr_b16 v[82:83], v4 offset:56320
    v_cvt_pk_bf16_f32 v125, v250, v251
    v_cvt_pk_bf16_f32 v126, v252, v253
    v_cvt_pk_bf16_f32 v127, v254, v255
    buffer_store_dwordx4 v[124:127], v0, s[36:39], s50 offen offset:3072 sc1
    s_waitcnt lgkmcnt(6)
    v_mfma_f32_32x32x16_bf16 v[48:63], v[88:91], v[212:215], v[48:63]
    ds_read_b64_tr_b16 v[84:85], v5 offset:55296
    ds_read_b64_tr_b16 v[86:87], v5 offset:56320
    v_mfma_f32_32x32x16_bf16 v[64:79], v[92:95], v[212:215], v[64:79]
    s_mov_b32 s58, 524288
    v_mov_b32 v8, 159744
GL_2001:
    ds_read_b32 v9, v8
    s_sub_u32 s58, s58, 1
    s_cbranch_scc1 GD_2002
    s_waitcnt lgkmcnt(0)
    v_readfirstlane_b32 s3, v9
    s_nop 1
    s_cmp_lt_u32 s3, 20
    s_cbranch_scc1 GL_2001
GD_2002:
    s_waitcnt lgkmcnt(0)
    s_waitcnt lgkmcnt(4)
    v_mfma_f32_32x32x16_bf16 v[48:63], v[96:99], v[216:219], v[48:63]
    v_mfma_f32_32x32x16_bf16 v[64:79], v[100:103], v[216:219], v[64:79]
    s_waitcnt lgkmcnt(0)
    v_mfma_f32_32x32x16_bf16 v[48:63], v[80:83], v[220:223], v[48:63]
    v_mfma_f32_32x32x16_bf16 v[64:79], v[84:87], v[220:223], v[64:79]
    s_mov_b64 exec, 1
    v_mov_b32 v8, 159744
    v_mov_b32 v9, 1
    ds_add_u32 v8, v9
    s_mov_b64 exec, -1
    v_mov_b32 v88, v244
    v_mov_b32 v89, v245
    v_mov_b32 v90, 0
    v_mov_b32 v91, 0
    v_mov_b32 v80, v242
    v_and_b32 v81, 0xffff, v242
    v_mov_b32 v82, 0
    v_mov_b32 v83, 0
    v_mov_b32 v84, v243
    v_and_b32 v85, 0xffff, v243
    v_mov_b32 v86, 0
    v_mov_b32 v87, 0
    v_mfma_f32_32x32x16_bf16 v[48:63], v[80:83], v[88:91], v[48:63]
    s_nop 0
    v_mfma_f32_32x32x16_bf16 v[64:79], v[84:87], v[88:91], v[64:79]
    s_nop 9
    v_mul_f32 v248, v48, v48
    v_mul_f32 v249, v49, v49
    v_mul_f32 v250, v50, v50
    v_mul_f32 v251, v51, v51
    v_mul_f32 v252, v52, v52
    v_mul_f32 v253, v53, v53
    v_mul_f32 v254, v54, v54
    v_mul_f32 v255, v55, v55
    v_fma_f32 v248, v248, v12, v10
    v_fma_f32 v249, v249, v12, v10
    v_fma_f32 v250, v250, v12, v10
    v_fma_f32 v251, v251, v12, v10
    v_fma_f32 v252, v252, v12, v10
    v_fma_f32 v253, v253, v12, v10
    v_fma_f32 v254, v254, v12, v10
    v_fma_f32 v255, v255, v12, v10
    v_mul_f32 v248, v248, v48
    v_mul_f32 v249, v249, v49
    v_mul_f32 v250, v250, v50
    v_mul_f32 v251, v251, v51
    v_mul_f32 v252, v252, v52
    v_mul_f32 v253, v253, v53
    v_mul_f32 v254, v254, v54
    v_mul_f32 v255, v255, v55
    v_exp_f32 v248, v248
    v_exp_f32 v249, v249
    v_exp_f32 v250, v250
    v_exp_f32 v251, v251
    v_exp_f32 v252, v252
    v_exp_f32 v253, v253
    v_exp_f32 v254, v254
    v_exp_f32 v255, v255
    v_fma_f32 v248, v248, v14, v14
    v_fma_f32 v249, v249, v14, v14
    v_fma_f32 v250, v250, v14, v14
    v_fma_f32 v251, v251, v14, v14
    v_fma_f32 v252, v252, v14, v14
    v_fma_f32 v253, v253, v14, v14
    v_fma_f32 v254, v254, v14, v14
    v_fma_f32 v255, v255, v14, v14
    v_rcp_f32 v248, v248
    v_rcp_f32 v249, v249
    v_rcp_f32 v250, v250
    v_rcp_f32 v251, v251
    v_rcp_f32 v252, v252
    v_rcp_f32 v253, v253
    v_rcp_f32 v254, v254
    v_rcp_f32 v255, v255
    v_mul_f32 v248, v248, v48
    v_mul_f32 v249, v249, v49
    v_mul_f32 v250, v250, v50
    v_mul_f32 v251, v251, v51
    v_mul_f32 v252, v252, v52
    v_mul_f32 v253, v253, v53
    v_mul_f32 v254, v254, v54
    v_mul_f32 v255, v255, v55
    v_cvt_pk_bf16_f32 v128, v248, v249
    v_cvt_pk_bf16_f32 v129, v250, v251
    v_cvt_pk_bf16_f32 v130, v252, v253
    v_cvt_pk_bf16_f32 v131, v254, v255
    buffer_store_dwordx4 v[128:131], v0, s[36:39], s27 offen offset:0 sc1
    v_mul_f32 v248, v56, v56
    v_mul_f32 v249, v57, v57
    v_mul_f32 v250, v58, v58
    v_mul_f32 v251, v59, v59
    v_mul_f32 v252, v60, v60
    v_mul_f32 v253, v61, v61
    v_mul_f32 v254, v62, v62
    v_mul_f32 v255, v63, v63
    v_fma_f32 v248, v248, v12, v10
    v_fma_f32 v249, v249, v12, v10
    v_fma_f32 v250, v250, v12, v10
    v_fma_f32 v251, v251, v12, v10
    v_fma_f32 v252, v252, v12, v10
    v_fma_f32 v253, v253, v12, v10
    v_fma_f32 v254, v254, v12, v10
    v_fma_f32 v255, v255, v12, v10
    v_mul_f32 v248, v248, v56
    v_mul_f32 v249, v249, v57
    v_mul_f32 v250, v250, v58
    v_mul_f32 v251, v251, v59
    v_mul_f32 v252, v252, v60
    v_mul_f32 v253, v253, v61
    v_mul_f32 v254, v254, v62
    v_mul_f32 v255, v255, v63
    v_exp_f32 v248, v248
    v_exp_f32 v249, v249
    v_exp_f32 v250, v250
    v_exp_f32 v251, v251
    v_exp_f32 v252, v252
    v_exp_f32 v253, v253
    v_exp_f32 v254, v254
    v_exp_f32 v255, v255
    v_fma_f32 v248, v248, v14, v14
    v_fma_f32 v249, v249, v14, v14
    v_fma_f32 v250, v250, v14, v14
    v_fma_f32 v251, v251, v14, v14
    v_fma_f32 v252, v252, v14, v14
    v_fma_f32 v253, v253, v14, v14
    v_fma_f32 v254, v254, v14, v14
    v_fma_f32 v255, v255, v14, v14
    v_rcp_f32 v248, v248
    v_rcp_f32 v249, v249
    v_rcp_f32 v250, v250
    v_rcp_f32 v251, v251
    v_rcp_f32 v252, v252
    v_rcp_f32 v253, v253
    v_rcp_f32 v254, v254
    v_rcp_f32 v255, v255
    v_mul_f32 v248, v248, v56
    v_mul_f32 v249, v249, v57
    v_mul_f32 v250, v250, v58
    v_mul_f32 v251, v251, v59
    v_mul_f32 v252, v252, v60
    v_mul_f32 v253, v253, v61
    v_mul_f32 v254, v254, v62
    v_mul_f32 v255, v255, v63
    v_cvt_pk_bf16_f32 v132, v248, v249
    v_cvt_pk_bf16_f32 v133, v250, v251
    v_cvt_pk_bf16_f32 v134, v252, v253
    v_cvt_pk_bf16_f32 v135, v254, v255
    buffer_store_dwordx4 v[132:135], v0, s[36:39], s27 offen offset:1024 sc1
    v_mul_f32 v248, v64, v64
    v_mul_f32 v249, v65, v65
    v_mul_f32 v250, v66, v66
    v_mul_f32 v251, v67, v67
    v_mul_f32 v252, v68, v68
    v_mul_f32 v253, v69, v69
    v_mul_f32 v254, v70, v70
    v_mul_f32 v255, v71, v71
    v_fma_f32 v248, v248, v12, v10
    v_fma_f32 v249, v249, v12, v10
    v_fma_f32 v250, v250, v12, v10
    v_fma_f32 v251, v251, v12, v10
    v_fma_f32 v252, v252, v12, v10
    v_fma_f32 v253, v253, v12, v10
    v_fma_f32 v254, v254, v12, v10
    v_fma_f32 v255, v255, v12, v10
    v_mul_f32 v248, v248, v64
    v_mul_f32 v249, v249, v65
    v_mul_f32 v250, v250, v66
    v_mul_f32 v251, v251, v67
    v_mul_f32 v252, v252, v68
    v_mul_f32 v253, v253, v69
    v_mul_f32 v254, v254, v70
    v_mul_f32 v255, v255, v71
    v_exp_f32 v248, v248
    v_exp_f32 v249, v249
    v_exp_f32 v250, v250
    v_exp_f32 v251, v251
    v_exp_f32 v252, v252
    v_exp_f32 v253, v253
    v_exp_f32 v254, v254
    v_exp_f32 v255, v255
    v_fma_f32 v248, v248, v14, v14
    v_fma_f32 v249, v249, v14, v14
    v_fma_f32 v250, v250, v14, v14
    v_fma_f32 v251, v251, v14, v14
    v_fma_f32 v252, v252, v14, v14
    v_fma_f32 v253, v253, v14, v14
    v_fma_f32 v254, v254, v14, v14
    v_fma_f32 v255, v255, v14, v14
    v_rcp_f32 v248, v248
    v_rcp_f32 v249, v249
    v_rcp_f32 v250, v250
    v_rcp_f32 v251, v251
    v_rcp_f32 v252, v252
    v_rcp_f32 v253, v253
    v_rcp_f32 v254, v254
    v_rcp_f32 v255, v255
    v_mul_f32 v248, v248, v64
    v_mul_f32 v249, v249, v65
    v_mul_f32 v250, v250, v66
    v_mul_f32 v251, v251, v67
    v_mul_f32 v252, v252, v68
    v_mul_f32 v253, v253, v69
    v_mul_f32 v254, v254, v70
    v_mul_f32 v255, v255, v71
    v_cvt_pk_bf16_f32 v136, v248, v249
    v_cvt_pk_bf16_f32 v137, v250, v251
    v_cvt_pk_bf16_f32 v138, v252, v253
    v_cvt_pk_bf16_f32 v139, v254, v255
    buffer_store_dwordx4 v[136:139], v0, s[36:39], s27 offen offset:2048 sc1
    v_mul_f32 v248, v72, v72
    v_mul_f32 v249, v73, v73
    v_mul_f32 v250, v74, v74
    v_mul_f32 v251, v75, v75
    v_mul_f32 v252, v76, v76
    v_mul_f32 v253, v77, v77
    v_mul_f32 v254, v78, v78
    v_mul_f32 v255, v79, v79
    v_fma_f32 v248, v248, v12, v10
    v_fma_f32 v249, v249, v12, v10
    v_fma_f32 v250, v250, v12, v10
    v_fma_f32 v251, v251, v12, v10
    v_fma_f32 v252, v252, v12, v10
    v_fma_f32 v253, v253, v12, v10
    v_fma_f32 v254, v254, v12, v10
    v_fma_f32 v255, v255, v12, v10
    v_mul_f32 v248, v248, v72
    v_mul_f32 v249, v249, v73
    v_mul_f32 v250, v250, v74
    v_mul_f32 v251, v251, v75
    v_mul_f32 v252, v252, v76
    v_mul_f32 v253, v253, v77
    v_mul_f32 v254, v254, v78
    v_mul_f32 v255, v255, v79
    v_exp_f32 v248, v248
    v_exp_f32 v249, v249
    v_exp_f32 v250, v250
    v_exp_f32 v251, v251
    v_exp_f32 v252, v252
    v_exp_f32 v253, v253
    v_exp_f32 v254, v254
    v_exp_f32 v255, v255
    v_fma_f32 v248, v248, v14, v14
    v_fma_f32 v249, v249, v14, v14
    v_fma_f32 v250, v250, v14, v14
    v_fma_f32 v251, v251, v14, v14
    v_fma_f32 v252, v252, v14, v14
    v_fma_f32 v253, v253, v14, v14
    v_fma_f32 v254, v254, v14, v14
    v_fma_f32 v255, v255, v14, v14
    v_rcp_f32 v248, v248
    v_rcp_f32 v249, v249
    v_rcp_f32 v250, v250
    v_rcp_f32 v251, v251
    v_rcp_f32 v252, v252
    v_rcp_f32 v253, v253
    v_rcp_f32 v254, v254
    v_rcp_f32 v255, v255
    v_mul_f32 v248, v248, v72
    v_mul_f32 v249, v249, v73
    v_mul_f32 v250, v250, v74
    v_mul_f32 v251, v251, v75
    v_mul_f32 v252, v252, v76
    v_mul_f32 v253, v253, v77
    v_mul_f32 v254, v254, v78
    v_mul_f32 v255, v255, v79
    v_cvt_pk_bf16_f32 v140, v248, v249
    v_cvt_pk_bf16_f32 v141, v250, v251
    v_cvt_pk_bf16_f32 v142, v252, v253
    v_cvt_pk_bf16_f32 v143, v254, v255
    buffer_store_dwordx4 v[140:143], v0, s[36:39], s27 offen offset:3072 sc1
    s_mov_b32 s40, s8
    s_mov_b32 s41, s9
    s_mov_b32 s42, 401408
    s_mov_b32 s43, 0x20000
    s_and_b32 s27, s2, 1
    s_mov_b32 s58, 524288
    v_mov_b32 v8, 159744
GL_35:
    ds_read_b32 v9, v8
    s_sub_u32 s58, s58, 1
    s_cbranch_scc1 GD_36
    s_waitcnt lgkmcnt(0)
    v_readfirstlane_b32 s3, v9
    s_nop 1
    s_cmp_lt_u32 s3, 24
    s_cbranch_scc1 GL_35
GD_36:
    s_waitcnt lgkmcnt(0)
    s_lshl_b32 s3, s54, 4
    s_add_u32 s3, s3, s55
    s_lshl_b32 s3, s3, 7
    s_add_u32 s53, s3, 22413312
    s_mul_i32 s3, s56, 112
    s_mul_i32 s26, s27, 56
    s_add_u32 s3, s3, s26
    s_lshl_b32 s3, s3, 10
    s_add_u32 s3, s3, 14680064
    v_add_u32 v4, s3, v0
    s_add_u32 s51, s45, 1
    s_cmp_eq_u32 s51, 7
    s_cselect_b32 s51, 0, s51
    s_lshl_b32 s51, s51, 13
    s_lshl_b32 s26, s54, 4
    s_mul_i32 s3, s27, 7
    s_add_u32 s3, s3, s26
    v_add_u32 v10, s3, v1
    v_lshlrev_b32 v10, 7, v10
    v_add_u32 v10, 22413312, v10
    s_lshl_b32 s3, s52, 3
    s_add_u32 s3, s3, s26
    v_and_b32 v14, 7, v1
    v_add_u32 v14, s3, v14
    v_lshlrev_b32 v14, 7, v14
    v_add_u32 v14, 22446080, v14
    s_waitcnt vmcnt(0)
    s_mov_b64 exec, 1
    v_mov_b32 v8, 159760
    v_mov_b32 v9, 1
    ds_add_rtn_u32 v8, v8, v9
    s_waitcnt lgkmcnt(0)
    v_readfirstlane_b32 s26, v8
    v_mov_b32 v8, 0
    s_nop 0
    s_cmp_eq_u32 s26, 3
    s_cselect_b32 s26, s53, 2147483648
    s_nop 0
    buffer_store_dword v9, v8, s[36:39], s26 offen sc1
    s_mov_b64 exec, -1
    s_add_u32 m0, s49, 0
    s_add_u32 s3, s57, 0
    buffer_load_dwordx4 v7, s[32:35], s3 offen lds
    s_add_u32 m0, s49, 1024
    s_add_u32 s3, s57, 7168
    buffer_load_dwordx4 v7, s[32:35], s3 offen lds
    s_add_u32 s57, s57, 57344
    s_cmp_eq_u32 s57, 802816
    s_cselect_b32 s57, 0, s57
    s_add_u32 m0, s49, 8192
    s_add_u32 s3, s57, 0
    buffer_load_dwordx4 v7, s[32:35], s3 offen lds
    s_add_u32 m0, s49, 9216
    s_add_u32 s3, s57, 7168
    buffer_load_dwordx4 v7, s[32:35], s3 offen lds
    s_add_u32 s57, s57, 57344
    s_cmp_eq_u32 s57, 802816
    s_cselect_b32 s57, 0, s57
    s_add_u32 m0, s49, 16384
    s_add_u32 s3, s57, 0
    buffer_load_dwordx4 v7, s[32:35], s3 offen lds
    s_add_u32 m0, s49, 17408
    s_add_u32 s3, s57, 7168
    buffer_load_dwordx4 v7, s[32:35], s3 offen lds
    s_add_u32 s57, s57, 57344
    s_cmp_eq_u32 s57, 802816
    s_cselect_b32 s57, 0, s57
    s_add_u32 m0, s49, 24576
    s_add_u32 s3, s57, 0
    buffer_load_dwordx4 v7, s[32:35], s3 offen lds
    s_add_u32 m0, s49, 25600
    s_add_u32 s3, s57, 7168
    buffer_load_dwordx4 v7, s[32:35], s3 offen lds
    s_add_u32 s57, s57, 57344
    s_cmp_eq_u32 s57, 802816
    s_cselect_b32 s57, 0, s57
    s_add_u32 m0, s49, 32768
    s_add_u32 s3, s57, 0
    buffer_load_dwordx4 v7, s[32:35], s3 offen lds
    s_add_u32 m0, s49, 33792
    s_add_u32 s3, s57, 7168
    buffer_load_dwordx4 v7, s[32:35], s3 offen lds
    s_add_u32 s57, s57, 57344
    s_cmp_eq_u32 s57, 802816
    s_cselect_b32 s57, 0, s57
    s_add_u32 m0, s49, 40960
    s_add_u32 s3, s57, 0
    buffer_load_dwordx4 v7, s[32:35], s3 offen lds
    s_add_u32 m0, s49, 41984
    s_add_u32 s3, s57, 7168
    buffer_load_dwordx4 v7, s[32:35], s3 offen lds
    s_add_u32 s57, s57, 57344
    s_cmp_eq_u32 s57, 802816
    s_cselect_b32 s57, 0, s57
    s_add_u32 m0, s49, 49152
    s_add_u32 s3, s57, 0
    buffer_load_dwordx4 v7, s[32:35], s3 offen lds
    s_add_u32 m0, s49, 50176
    s_add_u32 s3, s57, 7168
    buffer_load_dwordx4 v7, s[32:35], s3 offen lds
    s_add_u32 s57, s57, 57344
    s_cmp_eq_u32 s57, 802816
    s_cselect_b32 s57, 0, s57
    s_add_u32 m0, s49, 57344
    s_add_u32 s3, s57, 0
    buffer_load_dwordx4 v7, s[32:35], s3 offen lds
    s_add_u32 m0, s49, 58368
    s_add_u32 s3, s57, 7168
    buffer_load_dwordx4 v7, s[32:35], s3 offen lds
    s_add_u32 s57, s57, 57344
    s_cmp_eq_u32 s57, 802816
    s_cselect_b32 s57, 0, s57
    s_add_u32 m0, s49, 65536
    s_add_u32 s3, s57, 0
    buffer_load_dwordx4 v7, s[32:35], s3 offen lds
    s_add_u32 m0, s49, 66560
    s_add_u32 s3, s57, 7168
    buffer_load_dwordx4 v7, s[32:35], s3 offen lds
    s_add_u32 s57, s57, 57344
    s_cmp_eq_u32 s57, 802816
    s_cselect_b32 s57, 0, s57
    s_add_u32 m0, s49, 73728
    s_add_u32 s3, s57, 0
    buffer_load_dwordx4 v7, s[32:35], s3 offen lds
    s_add_u32 m0, s49, 74752
    s_add_u32 s3, s57, 7168
    buffer_load_dwordx4 v7, s[32:35], s3 offen lds
    s_add_u32 s57, s57, 57344
    s_cmp_eq_u32 s57, 802816
    s_cselect_b32 s57, 0, s57
    s_add_u32 m0, s49, 81920
    s_add_u32 s3, s57, 0
    buffer_load_dwordx4 v7, s[32:35], s3 offen lds
    s_add_u32 m0, s49, 82944
    s_add_u32 s3, s57, 7168
    buffer_load_dwordx4 v7, s[32:35], s3 offen lds
    s_add_u32 s57, s57, 57344
    s_cmp_eq_u32 s57, 802816
    s_cselect_b32 s57, 0, s57
    s_add_u32 m0, s49, 90112
    s_add_u32 s3, s57, 0
    buffer_load_dwordx4 v7, s[32:35], s3 offen lds
    s_add_u32 m0, s49, 91136
    s_add_u32 s3, s57, 7168
    buffer_load_dwordx4 v7, s[32:35], s3 offen lds
    s_add_u32 s57, s57, 57344
    s_cmp_eq_u32 s57, 802816
    s_cselect_b32 s57, 0, s57
    s_add_u32 m0, s49, 98304
    s_add_u32 s3, s57, 0
    buffer_load_dwordx4 v7, s[32:35], s3 offen lds
    s_add_u32 m0, s49, 99328
    s_add_u32 s3, s57, 7168
    buffer_load_dwordx4 v7, s[32:35], s3 offen lds
    s_add_u32 s57, s57, 57344
    s_cmp_eq_u32 s57, 802816
    s_cselect_b32 s57, 0, s57
    s_add_u32 m0, s49, 106496
    s_add_u32 s3, s57, 0
    buffer_load_dwordx4 v7, s[32:35], s3 offen lds
    s_add_u32 m0, s49, 107520
    s_add_u32 s3, s57, 7168
    buffer_load_dwordx4 v7, s[32:35], s3 offen lds
    s_add_u32 s57, s57, 57344
    s_cmp_eq_u32 s57, 802816
    s_cselect_b32 s57, 0, s57
    s_mul_i32 s3, s27, 802816
    s_mul_i32 s26, s46, 86016
    s_sub_u32 s3, s26, s3
    v_add_u32 v7, s3, v7
    s_mov_b32 s58, 65536
    s_bfm_b64 exec, 7, 0
PL_37:
    buffer_load_dword v9, v10, s[36:39], 0 offen sc1
    s_waitcnt vmcnt(0)
    v_cmp_eq_u32 vcc, 0, v9
    s_nop 1
    s_cbranch_vccz PD_38
    s_sleep 1
    s_sub_u32 s58, s58, 1
    s_cmp_lg_u32 s58, 0
    s_cbranch_scc1 PL_37
PD_38:
    s_mov_b64 exec, -1
    s_waitcnt lgkmcnt(0)
    s_mov_b64 exec, 1
    v_mov_b32 v8, 159744
    v_mov_b32 v9, 1
    ds_add_u32 v8, v9
    s_mov_b64 exec, -1
    s_mov_b32 s58, 524288
    v_mov_b32 v8, 159744
GL_39:
    ds_read_b32 v9, v8
    s_sub_u32 s58, s58, 1
    s_cbranch_scc1 GD_40
    s_waitcnt lgkmcnt(0)
    v_readfirstlane_b32 s3, v9
    s_nop 1
    s_cmp_lt_u32 s3, 28
    s_cbranch_scc1 GL_39
GD_40:
    s_waitcnt lgkmcnt(0)
    buffer_load_dwordx4 v[176:179], v4, s[36:39], s51 offen offset:0 sc1
    buffer_load_dwordx4 v[180:183], v4, s[36:39], s51 offen offset:1024 sc1
    s_mul_i32 s47, s46, 15360
    s_movk_i32 s49, 4096
    s_lshl_b32 s3, s48, 5
    s_lshl_b32 s26, s52, 4
    s_add_u32 s3, s3, s26
    s_lshl_b32 s3, s3, 10
    s_add_u32 s3, s3, 12582912
    v_add_u32 v12, s3, v0
    v_add_u32 v13, 8192, v12
    s_setprio 0
    ds_read_b64_tr_b16 v[80:81], v2 offset:0
    ds_read_b64_tr_b16 v[82:83], v2 offset:1024
    ds_read_b64_tr_b16 v[84:85], v3 offset:0
    ds_read_b64_tr_b16 v[86:87], v3 offset:1024
    ds_read_b64_tr_b16 v[88:89], v2 offset:2048
    ds_read_b64_tr_b16 v[90:91], v2 offset:3072
    ds_read_b64_tr_b16 v[92:93], v3 offset:2048
    ds_read_b64_tr_b16 v[94:95], v3 offset:3072
    ds_read_b64_tr_b16 v[96:97], v2 offset:4096
    ds_read_b64_tr_b16 v[98:99], v2 offset:5120
    ds_read_b64_tr_b16 v[100:101], v3 offset:4096
    ds_read_b64_tr_b16 v[102:103], v3 offset:5120
    s_waitcnt lgkmcnt(8)
    v_mfma_f32_32x32x16_bf16 v[16:31], v[80:83], v[112:115], 0
    ds_read_b64_tr_b16 v[104:105], v2 offset:6144
    ds_read_b64_tr_b16 v[106:107], v2 offset:7168
    v_mfma_f32_32x32x16_bf16 v[32:47], v[84:87], v[112:115], 0
    ds_read_b64_tr_b16 v[108:109], v3 offset:6144
    ds_read_b64_tr_b16 v[110:111], v3 offset:7168
    buffer_load_dwordx4 v[184:187], v4, s[36:39], s51 offen offset:2048 sc1
    buffer_load_dwordx4 v[188:191], v4, s[36:39], s51 offen offset:3072 sc1
    s_add_u32 s51, s51, 4096
    s_cmp_eq_u32 s51, 57344
    s_cselect_b32 s51, 0, s51
    s_waitcnt lgkmcnt(8)
    v_mfma_f32_32x32x16_bf16 v[16:31], v[88:91], v[116:119], v[16:31]
    ds_read_b64_tr_b16 v[80:81], v2 offset:8192
    ds_read_b64_tr_b16 v[82:83], v2 offset:9216
    v_mfma_f32_32x32x16_bf16 v[32:47], v[92:95], v[116:119], v[32:47]
    ds_read_b64_tr_b16 v[84:85], v3 offset:8192
    ds_read_b64_tr_b16 v[86:87], v3 offset:9216
    buffer_load_dwordx4 v[192:195], v4, s[36:39], s51 offen offset:0 sc1
    buffer_load_dwordx4 v[196:199], v4, s[36:39], s51 offen offset:1024 sc1
    s_waitcnt lgkmcnt(8)
    v_mfma_f32_32x32x16_bf16 v[16:31], v[96:99], v[120:123], v[16:31]
    ds_read_b64_tr_b16 v[88:89], v2 offset:10240
    ds_read_b64_tr_b16 v[90:91], v2 offset:11264
    v_mfma_f32_32x32x16_bf16 v[32:47], v[100:103], v[120:123], v[32:47]
    ds_read_b64_tr_b16 v[92:93], v3 offset:10240
    ds_read_b64_tr_b16 v[94:95], v3 offset:11264
    buffer_load_dwordx4 v[144:147], v4, s[36:39], s51 offen offset:2048 sc1
    buffer_load_dwordx4 v[148:151], v4, s[36:39], s51 offen offset:3072 sc1
    s_add_u32 s51, s51, 4096
    s_cmp_eq_u32 s51, 57344
    s_cselect_b32 s51, 0, s51
    s_waitcnt lgkmcnt(8)
    v_mfma_f32_32x32x16_bf16 v[16:31], v[104:107], v[124:127], v[16:31]
    ds_read_b64_tr_b16 v[96:97], v2 offset:12288
    ds_read_b64_tr_b16 v[98:99], v2 offset:13312
    v_mfma_f32_32x32x16_bf16 v[32:47], v[108:111], v[124:127], v[32:47]
    ds_read_b64_tr_b16 v[100:101], v3 offset:12288
    ds_read_b64_tr_b16 v[102:103], v3 offset:13312
    buffer_load_dwordx4 v[152:155], v4, s[36:39], s51 offen offset:0 sc1
    buffer_load_dwordx4 v[156:159], v4, s[36:39], s51 offen offset:1024 sc1
    s_waitcnt lgkmcnt(8)
    v_mfma_f32_32x32x16_bf16 v[16:31], v[80:83], v[128:131], v[16:31]
    ds_read_b64_tr_b16 v[104:105], v2 offset:14336
    ds_read_b64_tr_b16 v[106:107], v2 offset:15360
    v_mfma_f32_32x32x16_bf16 v[32:47], v[84:87], v[128:131], v[32:47]
    ds_read_b64_tr_b16 v[108:109], v3 offset:14336
    ds_read_b64_tr_b16 v[110:111], v3 offset:15360
    buffer_load_dwordx4 v[160:163], v4, s[36:39], s51 offen offset:2048 sc1
    buffer_load_dwordx4 v[164:167], v4, s[36:39], s51 offen offset:3072 sc1
    s_add_u32 s51, s51, 4096
    s_cmp_eq_u32 s51, 57344
    s_cselect_b32 s51, 0, s51
    s_waitcnt lgkmcnt(8)
    v_mfma_f32_32x32x16_bf16 v[16:31], v[88:91], v[132:135], v[16:31]
    ds_read_b64_tr_b16 v[80:81], v2 offset:16384
    ds_read_b64_tr_b16 v[82:83], v2 offset:17408
    v_mfma_f32_32x32x16_bf16 v[32:47], v[92:95], v[132:135], v[32:47]
    ds_read_b64_tr_b16 v[84:85], v3 offset:16384
    ds_read_b64_tr_b16 v[86:87], v3 offset:17408
    s_waitcnt lgkmcnt(8)
    v_mfma_f32_32x32x16_bf16 v[16:31], v[96:99], v[136:139], v[16:31]
    ds_read_b64_tr_b16 v[88:89], v2 offset:18432
    ds_read_b64_tr_b16 v[90:91], v2 offset:19456
    v_mfma_f32_32x32x16_bf16 v[32:47], v[100:103], v[136:139], v[32:47]
    ds_read_b64_tr_b16 v[92:93], v3 offset:18432
    ds_read_b64_tr_b16 v[94:95], v3 offset:19456
    s_waitcnt lgkmcnt(8)
    v_mfma_f32_32x32x16_bf16 v[16:31], v[104:107], v[140:143], v[16:31]
    ds_read_b64_tr_b16 v[96:97], v2 offset:20480
    ds_read_b64_tr_b16 v[98:99], v2 offset:21504
    v_mfma_f32_32x32x16_bf16 v[32:47], v[108:111], v[140:143], v[32:47]
    ds_read_b64_tr_b16 v[100:101], v3 offset:20480
    ds_read_b64_tr_b16 v[102:103], v3 offset:21504
    s_waitcnt vmcnt(11) lgkmcnt(8)
    v_mfma_f32_32x32x16_bf16 v[16:31], v[80:83], v[176:179], v[16:31]
    ds_read_b64_tr_b16 v[104:105], v2 offset:22528
    ds_read_b64_tr_b16 v[106:107], v2 offset:23552
    v_mfma_f32_32x32x16_bf16 v[32:47], v[84:87], v[176:179], v[32:47]
    ds_read_b64_tr_b16 v[108:109], v3 offset:22528
    ds_read_b64_tr_b16 v[110:111], v3 offset:23552
    buffer_load_dwordx4 v[168:171], v4, s[36:39], s51 offen offset:0 sc1
    s_waitcnt vmcnt(11) lgkmcnt(8)
    v_mfma_f32_32x32x16_bf16 v[16:31], v[88:91], v[180:183], v[16:31]
    ds_read_b64_tr_b16 v[80:81], v2 offset:24576
    ds_read_b64_tr_b16 v[82:83], v2 offset:25600
    v_mfma_f32_32x32x16_bf16 v[32:47], v[92:95], v[180:183], v[32:47]
    ds_read_b64_tr_b16 v[84:85], v3 offset:24576
    ds_read_b64_tr_b16 v[86:87], v3 offset:25600
    buffer_load_dwordx4 v[172:175], v4, s[36:39], s51 offen offset:1024 sc1
    s_waitcnt vmcnt(11) lgkmcnt(8)
    v_mfma_f32_32x32x16_bf16 v[16:31], v[96:99], v[184:187], v[16:31]
    ds_read_b64_tr_b16 v[88:89], v2 offset:26624
    ds_read_b64_tr_b16 v[90:91], v2 offset:27648
    v_mfma_f32_32x32x16_bf16 v[32:47], v[100:103], v[184:187], v[32:47]
    ds_read_b64_tr_b16 v[92:93], v3 offset:26624
    ds_read_b64_tr_b16 v[94:95], v3 offset:27648
    buffer_load_dwordx4 v[176:179], v4, s[36:39], s51 offen offset:2048 sc1
    s_waitcnt vmcnt(11) lgkmcnt(8)
    v_mfma_f32_32x32x16_bf16 v[16:31], v[104:107], v[188:191], v[16:31]
    ds_read_b64_tr_b16 v[96:97], v2 offset:28672
    ds_read_b64_tr_b16 v[98:99], v2 offset:29696
    v_mfma_f32_32x32x16_bf16 v[32:47], v[108:111], v[188:191], v[32:47]
    ds_read_b64_tr_b16 v[100:101], v3 offset:28672
    ds_read_b64_tr_b16 v[102:103], v3 offset:29696
    buffer_load_dwordx4 v[180:183], v4, s[36:39], s51 offen offset:3072 sc1
    s_add_u32 s51, s51, 4096
    s_cmp_eq_u32 s51, 57344
    s_cselect_b32 s51, 0, s51
    s_waitcnt vmcnt(11) lgkmcnt(8)
    v_mfma_f32_32x32x16_bf16 v[16:31], v[80:83], v[192:195], v[16:31]
    ds_read_b64_tr_b16 v[104:105], v2 offset:30720
    ds_read_b64_tr_b16 v[106:107], v2 offset:31744
    v_mfma_f32_32x32x16_bf16 v[32:47], v[84:87], v[192:195], v[32:47]
    ds_read_b64_tr_b16 v[108:109], v3 offset:30720
    ds_read_b64_tr_b16 v[110:111], v3 offset:31744
    buffer_load_dwordx4 v[184:187], v4, s[36:39], s51 offen offset:0 sc1
    s_waitcnt vmcnt(11) lgkmcnt(8)
    v_mfma_f32_32x32x16_bf16 v[16:31], v[88:91], v[196:199], v[16:31]
    ds_read_b64_tr_b16 v[80:81], v2 offset:32768
    ds_read_b64_tr_b16 v[82:83], v2 offset:33792
    v_mfma_f32_32x32x16_bf16 v[32:47], v[92:95], v[196:199], v[32:47]
    ds_read_b64_tr_b16 v[84:85], v3 offset:32768
    ds_read_b64_tr_b16 v[86:87], v3 offset:33792
    buffer_load_dwordx4 v[188:191], v4, s[36:39], s51 offen offset:1024 sc1
    s_waitcnt vmcnt(11) lgkmcnt(8)
    v_mfma_f32_32x32x16_bf16 v[16:31], v[96:99], v[144:147], v[16:31]
    ds_read_b64_tr_b16 v[88:89], v2 offset:34816
    ds_read_b64_tr_b16 v[90:91], v2 offset:35840
    v_mfma_f32_32x32x16_bf16 v[32:47], v[100:103], v[144:147], v[32:47]
    ds_read_b64_tr_b16 v[92:93], v3 offset:34816
    ds_read_b64_tr_b16 v[94:95], v3 offset:35840
    buffer_load_dwordx4 v[192:195], v4, s[36:39], s51 offen offset:2048 sc1
    s_waitcnt vmcnt(11) lgkmcnt(8)
    v_mfma_f32_32x32x16_bf16 v[16:31], v[104:107], v[148:151], v[16:31]
    ds_read_b64_tr_b16 v[96:97], v2 offset:36864
    ds_read_b64_tr_b16 v[98:99], v2 offset:37888
    v_mfma_f32_32x32x16_bf16 v[32:47], v[108:111], v[148:151], v[32:47]
    ds_read_b64_tr_b16 v[100:101], v3 offset:36864
    ds_read_b64_tr_b16 v[102:103], v3 offset:37888
    buffer_load_dwordx4 v[196:199], v4, s[36:39], s51 offen offset:3072 sc1
    s_add_u32 s51, s51, 4096
    s_cmp_eq_u32 s51, 57344
    s_cselect_b32 s51, 0, s51
    s_waitcnt vmcnt(11) lgkmcnt(8)
    v_mfma_f32_32x32x16_bf16 v[16:31], v[80:83], v[152:155], v[16:31]
    ds_read_b64_tr_b16 v[104:105], v2 offset:38912
    ds_read_b64_tr_b16 v[106:107], v2 offset:39936
    v_mfma_f32_32x32x16_bf16 v[32:47], v[84:87], v[152:155], v[32:47]
    ds_read_b64_tr_b16 v[108:109], v3 offset:38912
    ds_read_b64_tr_b16 v[110:111], v3 offset:39936
    buffer_load_dwordx4 v[144:147], v4, s[36:39], s51 offen offset:0 sc1
    s_waitcnt vmcnt(11) lgkmcnt(8)
    v_mfma_f32_32x32x16_bf16 v[16:31], v[88:91], v[156:159], v[16:31]
    ds_read_b64_tr_b16 v[80:81], v2 offset:40960
    ds_read_b64_tr_b16 v[82:83], v2 offset:41984
    v_mfma_f32_32x32x16_bf16 v[32:47], v[92:95], v[156:159], v[32:47]
    ds_read_b64_tr_b16 v[84:85], v3 offset:40960
    ds_read_b64_tr_b16 v[86:87], v3 offset:41984
    buffer_load_dwordx4 v[148:151], v4, s[36:39], s51 offen offset:1024 sc1
    s_waitcnt vmcnt(11) lgkmcnt(8)
    v_mfma_f32_32x32x16_bf16 v[16:31], v[96:99], v[160:163], v[16:31]
    ds_read_b64_tr_b16 v[88:89], v2 offset:43008
    ds_read_b64_tr_b16 v[90:91], v2 offset:44032
    v_mfma_f32_32x32x16_bf16 v[32:47], v[100:103], v[160:163], v[32:47]
    ds_read_b64_tr_b16 v[92:93], v3 offset:43008
    ds_read_b64_tr_b16 v[94:95], v3 offset:44032
    buffer_load_dwordx4 v[152:155], v4, s[36:39], s51 offen offset:2048 sc1
    s_waitcnt vmcnt(11) lgkmcnt(8)
    v_mfma_f32_32x32x16_bf16 v[16:31], v[104:107], v[164:167], v[16:31]
    ds_read_b64_tr_b16 v[96:97], v2 offset:45056
    ds_read_b64_tr_b16 v[98:99], v2 offset:46080
    v_mfma_f32_32x32x16_bf16 v[32:47], v[108:111], v[164:167], v[32:47]
    ds_read_b64_tr_b16 v[100:101], v3 offset:45056
    ds_read_b64_tr_b16 v[102:103], v3 offset:46080
    buffer_load_dwordx4 v[156:159], v4, s[36:39], s51 offen offset:3072 sc1
    s_add_u32 s51, s51, 4096
    s_cmp_eq_u32 s51, 57344
    s_cselect_b32 s51, 0, s51
    s_waitcnt vmcnt(11) lgkmcnt(8)
    v_mfma_f32_32x32x16_bf16 v[16:31], v[80:83], v[168:171], v[16:31]
    ds_read_b64_tr_b16 v[104:105], v2 offset:47104
    ds_read_b64_tr_b16 v[106:107], v2 offset:48128
    v_mfma_f32_32x32x16_bf16 v[32:47], v[84:87], v[168:171], v[32:47]
    ds_read_b64_tr_b16 v[108:109], v3 offset:47104
    ds_read_b64_tr_b16 v[110:111], v3 offset:48128
    buffer_load_dwordx4 v[160:163], v4, s[36:39], s51 offen offset:0 sc1
    s_waitcnt vmcnt(11) lgkmcnt(8)
    v_mfma_f32_32x32x16_bf16 v[16:31], v[88:91], v[172:175], v[16:31]
    ds_read_b64_tr_b16 v[80:81], v2 offset:49152
    ds_read_b64_tr_b16 v[82:83], v2 offset:50176
    v_mfma_f32_32x32x16_bf16 v[32:47], v[92:95], v[172:175], v[32:47]
    ds_read_b64_tr_b16 v[84:85], v3 offset:49152
    ds_read_b64_tr_b16 v[86:87], v3 offset:50176
    buffer_load_dwordx4 v[164:167], v4, s[36:39], s51 offen offset:1024 sc1
    s_waitcnt vmcnt(11) lgkmcnt(8)
    v_mfma_f32_32x32x16_bf16 v[16:31], v[96:99], v[176:179], v[16:31]
    ds_read_b64_tr_b16 v[88:89], v2 offset:51200
    ds_read_b64_tr_b16 v[90:91], v2 offset:52224
    v_mfma_f32_32x32x16_bf16 v[32:47], v[100:103], v[176:179], v[32:47]
    ds_read_b64_tr_b16 v[92:93], v3 offset:51200
    ds_read_b64_tr_b16 v[94:95], v3 offset:52224
    buffer_load_dwordx4 v[168:171], v4, s[36:39], s51 offen offset:2048 sc1
    s_waitcnt vmcnt(11) lgkmcnt(8)
    v_mfma_f32_32x32x16_bf16 v[16:31], v[104:107], v[180:183], v[16:31]
    ds_read_b64_tr_b16 v[96:97], v2 offset:53248
    ds_read_b64_tr_b16 v[98:99], v2 offset:54272
    v_mfma_f32_32x32x16_bf16 v[32:47], v[108:111], v[180:183], v[32:47]
    ds_read_b64_tr_b16 v[100:101], v3 offset:53248
    ds_read_b64_tr_b16 v[102:103], v3 offset:54272
    buffer_load_dwordx4 v[172:175], v4, s[36:39], s51 offen offset:3072 sc1
    s_add_u32 s51, s51, 4096
    s_cmp_eq_u32 s51, 57344
    s_cselect_b32 s51, 0, s51
    s_waitcnt vmcnt(11) lgkmcnt(8)
    v_mfma_f32_32x32x16_bf16 v[16:31], v[80:83], v[184:187], v[16:31]
    ds_read_b64_tr_b16 v[104:105], v2 offset:55296
    ds_read_b64_tr_b16 v[106:107], v2 offset:56320
    v_mfma_f32_32x32x16_bf16 v[32:47], v[84:87], v[184:187], v[32:47]
    ds_read_b64_tr_b16 v[108:109], v3 offset:55296
    ds_read_b64_tr_b16 v[110:111], v3 offset:56320
    buffer_load_dwordx4 v[176:179], v4, s[36:39], s51 offen offset:0 sc1
    s_waitcnt vmcnt(11) lgkmcnt(8)
    v_mfma_f32_32x32x16_bf16 v[16:31], v[88:91], v[188:191], v[16:31]
    ds_read_b64_tr_b16 v[80:81], v2 offset:57344
    ds_read_b64_tr_b16 v[82:83], v2 offset:58368
    v_mfma_f32_32x32x16_bf16 v[32:47], v[92:95], v[188:191], v[32:47]
    ds_read_b64_tr_b16 v[84:85], v3 offset:57344
    ds_read_b64_tr_b16 v[86:87], v3 offset:58368
    buffer_load_dwordx4 v[180:183], v4, s[36:39], s51 offen offset:1024 sc1
    s_waitcnt vmcnt(11) lgkmcnt(8)
    v_mfma_f32_32x32x16_bf16 v[16:31], v[96:99], v[192:195], v[16:31]
    ds_read_b64_tr_b16 v[88:89], v2 offset:59392
    ds_read_b64_tr_b16 v[90:91], v2 offset:60416
    v_mfma_f32_32x32x16_bf16 v[32:47], v[100:103], v[192:195], v[32:47]
    ds_read_b64_tr_b16 v[92:93], v3 offset:59392
    ds_read_b64_tr_b16 v[94:95], v3 offset:60416
    buffer_load_dwordx4 v[184:187], v4, s[36:39], s51 offen offset:2048 sc1
    s_waitcnt vmcnt(11) lgkmcnt(8)
    v_mfma_f32_32x32x16_bf16 v[16:31], v[104:107], v[196:199], v[16:31]
    ds_read_b64_tr_b16 v[96:97], v2 offset:61440
    ds_read_b64_tr_b16 v[98:99], v2 offset:62464
    v_mfma_f32_32x32x16_bf16 v[32:47], v[108:111], v[196:199], v[32:47]
    ds_read_b64_tr_b16 v[100:101], v3 offset:61440
    ds_read_b64_tr_b16 v[102:103], v3 offset:62464
    buffer_load_dwordx4 v[188:191], v4, s[36:39], s51 offen offset:3072 sc1
    s_add_u32 s51, s51, 4096
    s_cmp_eq_u32 s51, 57344
    s_cselect_b32 s51, 0, s51
    s_waitcnt vmcnt(11) lgkmcnt(8)
    v_mfma_f32_32x32x16_bf16 v[16:31], v[80:83], v[144:147], v[16:31]
    ds_read_b64_tr_b16 v[104:105], v2 offset:63488
    ds_read_b64_tr_b16 v[106:107], v2 offset:64512
    v_mfma_f32_32x32x16_bf16 v[32:47], v[84:87], v[144:147], v[32:47]
    ds_read_b64_tr_b16 v[108:109], v3 offset:63488
    ds_read_b64_tr_b16 v[110:111], v3 offset:64512
    buffer_load_dwordx4 v[192:195], v4, s[36:39], s51 offen offset:0 sc1
    s_waitcnt vmcnt(11) lgkmcnt(8)
    v_mfma_f32_32x32x16_bf16 v[16:31], v[88:91], v[148:151], v[16:31]
    v_add_u32 v2, 0x10000, v2
    v_add_u32 v3, 0x10000, v3
    ds_read_b64_tr_b16 v[80:81], v2 offset:0
    ds_read_b64_tr_b16 v[82:83], v2 offset:1024
    v_mfma_f32_32x32x16_bf16 v[32:47], v[92:95], v[148:151], v[32:47]
    ds_read_b64_tr_b16 v[84:85], v3 offset:0
    ds_read_b64_tr_b16 v[86:87], v3 offset:1024
    buffer_load_dwordx4 v[196:199], v4, s[36:39], s51 offen offset:1024 sc1
    s_waitcnt vmcnt(11) lgkmcnt(8)
    v_mfma_f32_32x32x16_bf16 v[16:31], v[96:99], v[152:155], v[16:31]
    ds_read_b64_tr_b16 v[88:89], v2 offset:2048
    ds_read_b64_tr_b16 v[90:91], v2 offset:3072
    v_mfma_f32_32x32x16_bf16 v[32:47], v[100:103], v[152:155], v[32:47]
    ds_read_b64_tr_b16 v[92:93], v3 offset:2048
    ds_read_b64_tr_b16 v[94:95], v3 offset:3072
    buffer_load_dwordx4 v[144:147], v4, s[36:39], s51 offen offset:2048 sc1
    s_waitcnt vmcnt(11) lgkmcnt(8)
    v_mfma_f32_32x32x16_bf16 v[16:31], v[104:107], v[156:159], v[16:31]
    ds_read_b64_tr_b16 v[96:97], v2 offset:4096
    ds_read_b64_tr_b16 v[98:99], v2 offset:5120
    v_mfma_f32_32x32x16_bf16 v[32:47], v[108:111], v[156:159], v[32:47]
    ds_read_b64_tr_b16 v[100:101], v3 offset:4096
    ds_read_b64_tr_b16 v[102:103], v3 offset:5120
    buffer_load_dwordx4 v[148:151], v4, s[36:39], s51 offen offset:3072 sc1
    s_add_u32 s51, s51, 4096
    s_cmp_eq_u32 s51, 57344
    s_cselect_b32 s51, 0, s51
    s_mov_b64 exec, 1
    v_mov_b32 v8, 159744
    v_mov_b32 v9, 1
    ds_add_u32 v8, v9
    s_mov_b64 exec, -1
    s_waitcnt vmcnt(11) lgkmcnt(8)
    v_mfma_f32_32x32x16_bf16 v[16:31], v[80:83], v[160:163], v[16:31]
    ds_read_b64_tr_b16 v[104:105], v2 offset:6144
    ds_read_b64_tr_b16 v[106:107], v2 offset:7168
    v_mfma_f32_32x32x16_bf16 v[32:47], v[84:87], v[160:163], v[32:47]
    ds_read_b64_tr_b16 v[108:109], v3 offset:6144
    ds_read_b64_tr_b16 v[110:111], v3 offset:7168
    buffer_load_dwordx4 v[152:155], v4, s[36:39], s51 offen offset:0 sc1
    s_waitcnt vmcnt(11) lgkmcnt(8)
    v_mfma_f32_32x32x16_bf16 v[16:31], v[88:91], v[164:167], v[16:31]
    ds_read_b64_tr_b16 v[80:81], v2 offset:8192
    ds_read_b64_tr_b16 v[82:83], v2 offset:9216
    v_mfma_f32_32x32x16_bf16 v[32:47], v[92:95], v[164:167], v[32:47]
    ds_read_b64_tr_b16 v[84:85], v3 offset:8192
    ds_read_b64_tr_b16 v[86:87], v3 offset:9216
    buffer_load_dwordx4 v[156:159], v4, s[36:39], s51 offen offset:1024 sc1
    s_waitcnt vmcnt(11) lgkmcnt(8)
    v_mfma_f32_32x32x16_bf16 v[16:31], v[96:99], v[168:171], v[16:31]
    ds_read_b64_tr_b16 v[88:89], v2 offset:10240
    ds_read_b64_tr_b16 v[90:91], v2 offset:11264
    v_mfma_f32_32x32x16_bf16 v[32:47], v[100:103], v[168:171], v[32:47]
    ds_read_b64_tr_b16 v[92:93], v3 offset:10240
    ds_read_b64_tr_b16 v[94:95], v3 offset:11264
    buffer_load_dwordx4 v[160:163], v4, s[36:39], s51 offen offset:2048 sc1
    s_waitcnt vmcnt(11) lgkmcnt(8)
    v_mfma_f32_32x32x16_bf16 v[16:31], v[104:107], v[172:175], v[16:31]
    ds_read_b64_tr_b16 v[96:97], v2 offset:12288
    ds_read_b64_tr_b16 v[98:99], v2 offset:13312
    v_mfma_f32_32x32x16_bf16 v[32:47], v[108:111], v[172:175], v[32:47]
    ds_read_b64_tr_b16 v[100:101], v3 offset:12288
    ds_read_b64_tr_b16 v[102:103], v3 offset:13312
    buffer_load_dwordx4 v[164:167], v4, s[36:39], s51 offen offset:3072 sc1
    s_add_u32 s51, s51, 4096
    s_cmp_eq_u32 s51, 57344
    s_cselect_b32 s51, 0, s51
    s_waitcnt vmcnt(11) lgkmcnt(8)
    v_mfma_f32_32x32x16_bf16 v[16:31], v[80:83], v[176:179], v[16:31]
    ds_read_b64_tr_b16 v[104:105], v2 offset:14336
    ds_read_b64_tr_b16 v[106:107], v2 offset:15360
    v_mfma_f32_32x32x16_bf16 v[32:47], v[84:87], v[176:179], v[32:47]
    ds_read_b64_tr_b16 v[108:109], v3 offset:14336
    ds_read_b64_tr_b16 v[110:111], v3 offset:15360
    buffer_load_dwordx4 v[168:171], v4, s[36:39], s51 offen offset:0 sc1
    s_waitcnt vmcnt(11) lgkmcnt(8)
    v_mfma_f32_32x32x16_bf16 v[16:31], v[88:91], v[180:183], v[16:31]
    ds_read_b64_tr_b16 v[80:81], v2 offset:16384
    ds_read_b64_tr_b16 v[82:83], v2 offset:17408
    v_mfma_f32_32x32x16_bf16 v[32:47], v[92:95], v[180:183], v[32:47]
    ds_read_b64_tr_b16 v[84:85], v3 offset:16384
    ds_read_b64_tr_b16 v[86:87], v3 offset:17408
    buffer_load_dwordx4 v[172:175], v4, s[36:39], s51 offen offset:1024 sc1
    s_waitcnt vmcnt(11) lgkmcnt(8)
    v_mfma_f32_32x32x16_bf16 v[16:31], v[96:99], v[184:187], v[16:31]
    ds_read_b64_tr_b16 v[88:89], v2 offset:18432
    ds_read_b64_tr_b16 v[90:91], v2 offset:19456
    v_mfma_f32_32x32x16_bf16 v[32:47], v[100:103], v[184:187], v[32:47]
    ds_read_b64_tr_b16 v[92:93], v3 offset:18432
    ds_read_b64_tr_b16 v[94:95], v3 offset:19456
    buffer_load_dwordx4 v[176:179], v4, s[36:39], s51 offen offset:2048 sc1
    s_waitcnt vmcnt(11) lgkmcnt(8)
    v_mfma_f32_32x32x16_bf16 v[16:31], v[104:107], v[188:191], v[16:31]
    ds_read_b64_tr_b16 v[96:97], v2 offset:20480
    ds_read_b64_tr_b16 v[98:99], v2 offset:21504
    v_mfma_f32_32x32x16_bf16 v[32:47], v[108:111], v[188:191], v[32:47]
    ds_read_b64_tr_b16 v[100:101], v3 offset:20480
    ds_read_b64_tr_b16 v[102:103], v3 offset:21504
    buffer_load_dwordx4 v[180:183], v4, s[36:39], s51 offen offset:3072 sc1
    s_add_u32 s51, s51, 4096
    s_cmp_eq_u32 s51, 57344
    s_cselect_b32 s51, 0, s51
    s_waitcnt vmcnt(11) lgkmcnt(8)
    v_mfma_f32_32x32x16_bf16 v[16:31], v[80:83], v[192:195], v[16:31]
    ds_read_b64_tr_b16 v[104:105], v2 offset:22528
    ds_read_b64_tr_b16 v[106:107], v2 offset:23552
    v_mfma_f32_32x32x16_bf16 v[32:47], v[84:87], v[192:195], v[32:47]
    ds_read_b64_tr_b16 v[108:109], v3 offset:22528
    ds_read_b64_tr_b16 v[110:111], v3 offset:23552
    buffer_load_dwordx4 v[184:187], v4, s[36:39], s51 offen offset:0 sc1
    s_mov_b32 s58, 524288
    v_mov_b32 v8, 159744
GL_41:
    ds_read_b32 v9, v8
    s_sub_u32 s58, s58, 1
    s_cbranch_scc1 GD_42
    s_waitcnt lgkmcnt(0)
    v_readfirstlane_b32 s3, v9
    s_nop 1
    s_cmp_lt_u32 s3, 32
    s_cbranch_scc1 GL_41
GD_42:
    s_waitcnt lgkmcnt(0)
    s_add_u32 m0, s47, 0
    s_mov_b32 s3, 0
    buffer_load_dwordx4 v7, s[40:43], s3 offen lds
    s_waitcnt vmcnt(12) lgkmcnt(8)
    v_mfma_f32_32x32x16_bf16 v[16:31], v[88:91], v[196:199], v[16:31]
    ds_read_b64_tr_b16 v[80:81], v2 offset:24576
    ds_read_b64_tr_b16 v[82:83], v2 offset:25600
    v_mfma_f32_32x32x16_bf16 v[32:47], v[92:95], v[196:199], v[32:47]
    ds_read_b64_tr_b16 v[84:85], v3 offset:24576
    ds_read_b64_tr_b16 v[86:87], v3 offset:25600
    buffer_load_dwordx4 v[188:191], v4, s[36:39], s51 offen offset:1024 sc1
    s_add_u32 m0, s47, 1024
    s_mov_b32 s3, 7168
    buffer_load_dwordx4 v7, s[40:43], s3 offen lds
    s_waitcnt vmcnt(13) lgkmcnt(8)
    v_mfma_f32_32x32x16_bf16 v[16:31], v[96:99], v[144:147], v[16:31]
    ds_read_b64_tr_b16 v[88:89], v2 offset:26624
    ds_read_b64_tr_b16 v[90:91], v2 offset:27648
    v_mfma_f32_32x32x16_bf16 v[32:47], v[100:103], v[144:147], v[32:47]
    ds_read_b64_tr_b16 v[92:93], v3 offset:26624
    ds_read_b64_tr_b16 v[94:95], v3 offset:27648
    buffer_load_dwordx4 v[192:195], v4, s[36:39], s51 offen offset:2048 sc1
    s_add_u32 m0, s47, 2048
    s_mov_b32 s3, 14336
    buffer_load_dwordx4 v7, s[40:43], s3 offen lds
    s_waitcnt vmcnt(14) lgkmcnt(8)
    v_mfma_f32_32x32x16_bf16 v[16:31], v[104:107], v[148:151], v[16:31]
    ds_read_b64_tr_b16 v[96:97], v2 offset:28672
    ds_read_b64_tr_b16 v[98:99], v2 offset:29696
    v_mfma_f32_32x32x16_bf16 v[32:47], v[108:111], v[148:151], v[32:47]
    ds_read_b64_tr_b16 v[100:101], v3 offset:28672
    ds_read_b64_tr_b16 v[102:103], v3 offset:29696
    buffer_load_dwordx4 v[196:199], v4, s[36:39], s51 offen offset:3072 sc1
    s_add_u32 m0, s47, 3072
    s_mov_b32 s3, 21504
    buffer_load_dwordx4 v7, s[40:43], s3 offen lds
    s_waitcnt vmcnt(15) lgkmcnt(8)
    v_mfma_f32_32x32x16_bf16 v[16:31], v[80:83], v[152:155], v[16:31]
    ds_read_b64_tr_b16 v[104:105], v2 offset:30720
    ds_read_b64_tr_b16 v[106:107], v2 offset:31744
    v_mfma_f32_32x32x16_bf16 v[32:47], v[84:87], v[152:155], v[32:47]
    ds_read_b64_tr_b16 v[108:109], v3 offset:30720
    ds_read_b64_tr_b16 v[110:111], v3 offset:31744
    s_add_u32 m0, s47, 4096
    s_mov_b32 s3, 28672
    buffer_load_dwordx4 v7, s[40:43], s3 offen lds
    s_waitcnt vmcnt(15) lgkmcnt(8)
    v_mfma_f32_32x32x16_bf16 v[16:31], v[88:91], v[156:159], v[16:31]
    ds_read_b64_tr_b16 v[80:81], v2 offset:32768
    ds_read_b64_tr_b16 v[82:83], v2 offset:33792
    v_mfma_f32_32x32x16_bf16 v[32:47], v[92:95], v[156:159], v[32:47]
    ds_read_b64_tr_b16 v[84:85], v3 offset:32768
    ds_read_b64_tr_b16 v[86:87], v3 offset:33792
    s_add_u32 m0, s47, 5120
    s_mov_b32 s3, 35840
    buffer_load_dwordx4 v7, s[40:43], s3 offen lds
    s_waitcnt vmcnt(15) lgkmcnt(8)
    v_mfma_f32_32x32x16_bf16 v[16:31], v[96:99], v[160:163], v[16:31]
    ds_read_b64_tr_b16 v[88:89], v2 offset:34816
    ds_read_b64_tr_b16 v[90:91], v2 offset:35840
    v_mfma_f32_32x32x16_bf16 v[32:47], v[100:103], v[160:163], v[32:47]
    ds_read_b64_tr_b16 v[92:93], v3 offset:34816
    ds_read_b64_tr_b16 v[94:95], v3 offset:35840
    s_add_u32 m0, s47, 6144
    s_mov_b32 s3, 43008
    buffer_load_dwordx4 v7, s[40:43], s3 offen lds
    s_waitcnt vmcnt(15) lgkmcnt(8)
    v_mfma_f32_32x32x16_bf16 v[16:31], v[104:107], v[164:167], v[16:31]
    ds_read_b64_tr_b16 v[96:97], v2 offset:36864
    ds_read_b64_tr_b16 v[98:99], v2 offset:37888
    v_mfma_f32_32x32x16_bf16 v[32:47], v[108:111], v[164:167], v[32:47]
    ds_read_b64_tr_b16 v[100:101], v3 offset:36864
    ds_read_b64_tr_b16 v[102:103], v3 offset:37888
    s_add_u32 m0, s47, 7168
    s_mov_b32 s3, 50176
    buffer_load_dwordx4 v7, s[40:43], s3 offen lds
    s_waitcnt vmcnt(15) lgkmcnt(8)
    v_mfma_f32_32x32x16_bf16 v[16:31], v[80:83], v[168:171], v[16:31]
    ds_read_b64_tr_b16 v[104:105], v2 offset:38912
    ds_read_b64_tr_b16 v[106:107], v2 offset:39936
    v_mfma_f32_32x32x16_bf16 v[32:47], v[84:87], v[168:171], v[32:47]
    ds_read_b64_tr_b16 v[108:109], v3 offset:38912
    ds_read_b64_tr_b16 v[110:111], v3 offset:39936
    s_add_u32 m0, s47, 8192
    s_mov_b32 s3, 57344
    buffer_load_dwordx4 v7, s[40:43], s3 offen lds
    s_waitcnt vmcnt(15) lgkmcnt(8)
    v_mfma_f32_32x32x16_bf16 v[16:31], v[88:91], v[172:175], v[16:31]
    ds_read_b64_tr_b16 v[80:81], v2 offset:40960
    ds_read_b64_tr_b16 v[82:83], v2 offset:41984
    v_mfma_f32_32x32x16_bf16 v[32:47], v[92:95], v[172:175], v[32:47]
    ds_read_b64_tr_b16 v[84:85], v3 offset:40960
    ds_read_b64_tr_b16 v[86:87], v3 offset:41984
    s_add_u32 m0, s47, 9216
    s_mov_b32 s3, 64512
    buffer_load_dwordx4 v7, s[40:43], s3 offen lds
    s_waitcnt vmcnt(15) lgkmcnt(8)
    v_mfma_f32_32x32x16_bf16 v[16:31], v[96:99], v[176:179], v[16:31]
    ds_read_b64_tr_b16 v[88:89], v2 offset:43008
    ds_read_b64_tr_b16 v[90:91], v2 offset:44032
    v_mfma_f32_32x32x16_bf16 v[32:47], v[100:103], v[176:179], v[32:47]
    ds_read_b64_tr_b16 v[92:93], v3 offset:43008
    ds_read_b64_tr_b16 v[94:95], v3 offset:44032
    s_add_u32 m0, s47, 10240
    s_mov_b32 s3, 71680
    buffer_load_dwordx4 v7, s[40:43], s3 offen lds
    s_waitcnt vmcnt(15) lgkmcnt(8)
    v_mfma_f32_32x32x16_bf16 v[16:31], v[104:107], v[180:183], v[16:31]
    ds_read_b64_tr_b16 v[96:97], v2 offset:45056
    ds_read_b64_tr_b16 v[98:99], v2 offset:46080
    v_mfma_f32_32x32x16_bf16 v[32:47], v[108:111], v[180:183], v[32:47]
    ds_read_b64_tr_b16 v[100:101], v3 offset:45056
    ds_read_b64_tr_b16 v[102:103], v3 offset:46080
    s_add_u32 m0, s47, 11264
    s_mov_b32 s3, 78848
    buffer_load_dwordx4 v7, s[40:43], s3 offen lds
    s_waitcnt vmcnt(15) lgkmcnt(8)
    v_mfma_f32_32x32x16_bf16 v[16:31], v[80:83], v[184:187], v[16:31]
    ds_read_b64_tr_b16 v[104:105], v2 offset:47104
    ds_read_b64_tr_b16 v[106:107], v2 offset:48128
    v_mfma_f32_32x32x16_bf16 v[32:47], v[84:87], v[184:187], v[32:47]
    ds_read_b64_tr_b16 v[108:109], v3 offset:47104
    ds_read_b64_tr_b16 v[110:111], v3 offset:48128
    s_add_u32 m0, s47, 12288
    s_mov_b32 s3, 86016
    buffer_load_dwordx4 v7, s[40:43], s3 offen lds
    s_waitcnt vmcnt(14) lgkmcnt(8)
    v_mfma_f32_32x32x16_bf16 v[16:31], v[88:91], v[188:191], v[16:31]
    v_mfma_f32_32x32x16_bf16 v[32:47], v[92:95], v[188:191], v[32:47]
    s_add_u32 m0, s47, 13312
    s_mov_b32 s3, 93184
    buffer_load_dwordx4 v7, s[40:43], s3 offen lds
    s_waitcnt vmcnt(13) lgkmcnt(4)
    v_mfma_f32_32x32x16_bf16 v[16:31], v[96:99], v[192:195], v[16:31]
    v_mfma_f32_32x32x16_bf16 v[32:47], v[100:103], v[192:195], v[32:47]
    s_add_u32 m0, s47, 14336
    s_mov_b32 s3, 100352
    buffer_load_dwordx4 v7, s[40:43], s3 offen lds
    buffer_load_dword v15, v14, s[36:39], 0 offen sc1
    s_waitcnt vmcnt(13) lgkmcnt(0)
    v_mfma_f32_32x32x16_bf16 v[16:31], v[104:107], v[196:199], v[16:31]
    v_mfma_f32_32x32x16_bf16 v[32:47], v[108:111], v[196:199], v[32:47]
    s_setprio 1
    s_lshl_b32 s53, s2, 7
    s_add_u32 s53, s53, 22478848
    s_lshl_b32 s3, s52, 6
    s_mul_i32 s26, s52, 30720
    s_add_u32 s26, s26, 0xffff0000
    v_xor_b32 v2, s3, v2
    v_xor_b32 v3, s3, v3
    v_add_u32 v2, s26, v2
    v_add_u32 v3, s26, v3
    s_xor_b32 s3, s44, 1
    s_mul_i32 s3, s3, 7
    s_add_u32 s3, s3, s45
    s_lshl_b32 s3, s3, 1
    s_and_b32 s26, s46, 1
    s_add_u32 s3, s3, s26
    s_lshl_b32 s3, s3, 12
    s_add_u32 s3, s3, 23068672
    s_cmp_eq_u32 s52, 0
    s_cselect_b32 s3, 2147483648, s3
    s_add_u32 s26, s3, 4096
    v_cvt_pk_bf16_f32 v112, v16, v17
    v_cvt_pk_bf16_f32 v113, v18, v19
    v_cvt_pk_bf16_f32 v114, v20, v21
    v_cvt_pk_bf16_f32 v115, v22, v23
    buffer_store_dwordx4 v[112:115], v0, s[36:39], s3 offen offset:0 sc1
    v_cvt_pk_bf16_f32 v116, v24, v25
    v_cvt_pk_bf16_f32 v117, v26, v27
    v_cvt_pk_bf16_f32 v118, v28, v29
    v_cvt_pk_bf16_f32 v119, v30, v31
    buffer_store_dwordx4 v[116:119], v0, s[36:39], s3 offen offset:1024 sc1
    v_cvt_pk_bf16_f32 v120, v32, v33
    v_cvt_pk_bf16_f32 v121, v34, v35
    v_cvt_pk_bf16_f32 v122, v36, v37
    v_cvt_pk_bf16_f32 v123, v38, v39
    buffer_store_dwordx4 v[120:123], v0, s[36:39], s3 offen offset:2048 sc1
    v_cvt_pk_bf16_f32 v124, v40, v41
    v_cvt_pk_bf16_f32 v125, v42, v43
    v_cvt_pk_bf16_f32 v126, v44, v45
    v_cvt_pk_bf16_f32 v127, v46, v47
    buffer_store_dwordx4 v[124:127], v0, s[36:39], s3 offen offset:3072 sc1
    s_mov_b32 s51, 0
    s_waitcnt vmcnt(4)
    s_mov_b64 exec, 1
    v_mov_b32 v8, 159768
    v_mov_b32 v9, 16
    ds_add_u32 v8, v9
    s_mov_b64 exec, -1
    v_cmp_eq_u32 vcc, 0, v15
    s_nop 1
    s_cbranch_vccz B_oready
    s_waitcnt vmcnt(0)
    s_mov_b64 exec, 1
    v_mov_b32 v8, 159776
    v_mov_b32 v9, 1
    ds_add_rtn_u32 v8, v8, v9
    s_waitcnt lgkmcnt(0)
    v_readfirstlane_b32 s26, v8
    v_mov_b32 v8, 0
    s_nop 0
    s_cmp_eq_u32 s26, 3
    s_cselect_b32 s26, s53, 2147483648
    s_nop 0
    buffer_store_dword v9, v8, s[36:39], s26 offen sc1
    s_mov_b64 exec, -1
    s_mov_b32 s51, 1
    s_mov_b32 s58, 65536
    s_bfm_b64 exec, 8, 0
PL_43:
    buffer_load_dword v9, v14, s[36:39], 0 offen sc1
    s_waitcnt vmcnt(0)
    v_cmp_eq_u32 vcc, 0, v9
    s_nop 1
    s_cbranch_vccz PD_44
    s_sleep 1
    s_sub_u32 s58, s58, 1
    s_cmp_lg_u32 s58, 0
    s_cbranch_scc1 PL_43
PD_44:
    s_mov_b64 exec, -1
B_oready:
    buffer_load_dwordx4 v[168:171], v12, s[36:39], 0 offen offset:0 sc1
    buffer_load_dwordx4 v[172:175], v12, s[36:39], 0 offen offset:1024 sc1
    buffer_load_dwordx4 v[176:179], v12, s[36:39], 0 offen offset:2048 sc1
    buffer_load_dwordx4 v[180:183], v12, s[36:39], 0 offen offset:3072 sc1
    buffer_load_dwordx4 v[184:187], v12, s[36:39], s49 offen offset:0 sc1
    buffer_load_dwordx4 v[188:191], v12, s[36:39], s49 offen offset:1024 sc1
    buffer_load_dwordx4 v[192:195], v12, s[36:39], s49 offen offset:2048 sc1
    buffer_load_dwordx4 v[196:199], v12, s[36:39], s49 offen offset:3072 sc1
    buffer_load_dwordx4 v[200:203], v13, s[36:39], 0 offen offset:0 sc1
    buffer_load_dwordx4 v[204:207], v13, s[36:39], 0 offen offset:1024 sc1
    buffer_load_dwordx4 v[208:211], v13, s[36:39], 0 offen offset:2048 sc1
    buffer_load_dwordx4 v[212:215], v13, s[36:39], 0 offen offset:3072 sc1
    buffer_load_dwordx4 v[216:219], v13, s[36:39], s49 offen offset:0 sc1
    buffer_load_dwordx4 v[220:223], v13, s[36:39], s49 offen offset:1024 sc1
    buffer_load_dwordx4 v[240:243], v13, s[36:39], s49 offen offset:2048 sc1
    buffer_load_dwordx4 v[244:247], v13, s[36:39], s49 offen offset:3072 sc1
    s_mul_i32 s27, s44, 7
    s_add_u32 s27, s27, s45
    s_lshl_b32 s27, s27, 1
    s_and_b32 s26, s46, 1
    s_add_u32 s27, s27, s26
    s_lshl_b32 s27, s27, 1
    s_add_u32 s27, s27, s52
    s_lshl_b32 s27, s27, 11
    s_add_u32 s50, s27, 23068672
    s_xor_b32 s3, s2, 1
    s_lshl_b32 s3, s3, 7
    s_add_u32 s3, s3, 22478848
    v_mov_b32 v14, s3
    s_cmp_eq_u32 s52, 0
    s_cbranch_scc1 B_keep
    v_mov_b32 v16, 0
    v_mov_b32 v17, 0
    v_mov_b32 v18, 0
    v_mov_b32 v19, 0
    v_mov_b32 v20, 0
    v_mov_b32 v21, 0
    v_mov_b32 v22, 0
    v_mov_b32 v23, 0
    v_mov_b32 v24, 0
    v_mov_b32 v25, 0
    v_mov_b32 v26, 0
    v_mov_b32 v27, 0
    v_mov_b32 v28, 0
    v_mov_b32 v29, 0
    v_mov_b32 v30, 0
    v_mov_b32 v31, 0
    v_mov_b32 v32, 0
    v_mov_b32 v33, 0
    v_mov_b32 v34, 0
    v_mov_b32 v35, 0
    v_mov_b32 v36, 0
    v_mov_b32 v37, 0
    v_mov_b32 v38, 0
    v_mov_b32 v39, 0
    v_mov_b32 v40, 0
    v_mov_b32 v41, 0
    v_mov_b32 v42, 0
    v_mov_b32 v43, 0
    v_mov_b32 v44, 0
    v_mov_b32 v45, 0
    v_mov_b32 v46, 0
    v_mov_b32 v47, 0
B_keep:
    s_mov_b32 s28, s20
    s_mov_b32 s29, s21
    s_mov_b32 s30, 1835008
    s_mov_b32 s31, 0x20000
    v_and_b32 v4, 31, v1
    s_and_b32 s26, s46, 1
    s_lshl_b32 s26, s26, 5
    v_add_u32 v4, s26, v4
    v_mul_u32_u24 v4, 144, v4
    v_lshrrev_b32 v9, 5, v1
    v_lshl_add_u32 v4, v9, 3, v4
    s_lshl_b32 s26, s52, 6
    s_add_u32 s26, s26, 61440
    v_add_u32 v4, s26, v4
    v_lshrrev_b32 v6, 3, v1
    s_lshl_b32 s26, s46, 4
    v_add_u32 v6, s26, v6
    v_and_b32 v9, 7, v1
    v_mul_u32_u24 v5, 144, v6
    v_lshl_add_u32 v5, v9, 4, v5
    v_add_u32 v5, 61440, v5
    v_mul_u32_u24 v6, 896, v6
    v_lshl_add_u32 v6, v9, 4, v6
    s_mul_i32 s27, s44, 57344
    s_lshl_b32 s26, s45, 7
    s_add_u32 s27, s27, s26
    s_add_u32 s62, s27, 7168
    s_lshl_b32 s26, s46, 12
    s_add_u32 s26, s26, 81920
    v_add_u32 v10, s26, v0
    v_xor_b32 v11, 8192, v10
    s_mov_b32 s58, 524288
    v_mov_b32 v8, 159768
GL_45:
    ds_read_b32 v9, v8
    s_sub_u32 s58, s58, 1
    s_cbranch_scc1 GD_46
    s_waitcnt lgkmcnt(0)
    v_readfirstlane_b32 s3, v9
    s_nop 1
    s_bfe_u32 s3, s3, 262148
    s_cmp_lt_u32 s3, 4
    s_cbranch_scc1 GL_45
GD_46:
    s_waitcnt lgkmcnt(0)
    ds_read_b64_tr_b16 v[80:81], v2 offset:0
    ds_read_b64_tr_b16 v[82:83], v2 offset:1024
    ds_read_b64_tr_b16 v[84:85], v3 offset:0
    ds_read_b64_tr_b16 v[86:87], v3 offset:1024
    ds_read_b64_tr_b16 v[88:89], v2 offset:2048
    ds_read_b64_tr_b16 v[90:91], v2 offset:3072
    ds_read_b64_tr_b16 v[92:93], v3 offset:2048
    ds_read_b64_tr_b16 v[94:95], v3 offset:3072
    ds_read_b64_tr_b16 v[96:97], v2 offset:3584
    ds_read_b64_tr_b16 v[98:99], v2 offset:4608
    ds_read_b64_tr_b16 v[100:101], v3 offset:3584
    ds_read_b64_tr_b16 v[102:103], v3 offset:4608
    s_waitcnt vmcnt(16)
    s_cmp_lg_u32 s51, 0
    s_cbranch_scc1 B_sigd
    s_mov_b64 exec, 1
    v_mov_b32 v8, 159776
    v_mov_b32 v9, 1
    ds_add_rtn_u32 v8, v8, v9
    s_waitcnt lgkmcnt(0)
    v_readfirstlane_b32 s26, v8
    v_mov_b32 v8, 0
    s_nop 0
    s_cmp_eq_u32 s26, 3
    s_cselect_b32 s26, s53, 2147483648
    s_nop 0
    buffer_store_dword v9, v8, s[36:39], s26 offen sc1
    s_mov_b64 exec, -1
B_sigd:
    s_waitcnt vmcnt(15) lgkmcnt(8)
    v_mfma_f32_32x32x16_bf16 v[16:31], v[80:83], v[168:171], v[16:31]
    v_mfma_f32_32x32x16_bf16 v[32:47], v[84:87], v[168:171], v[32:47]
    ds_read_b64_tr_b16 v[104:105], v2 offset:5632
    ds_read_b64_tr_b16 v[106:107], v2 offset:6656
    ds_read_b64_tr_b16 v[108:109], v3 offset:5632
    ds_read_b64_tr_b16 v[110:111], v3 offset:6656
    s_waitcnt vmcnt(14) lgkmcnt(8)
    v_mfma_f32_32x32x16_bf16 v[16:31], v[88:91], v[172:175], v[16:31]
    v_mfma_f32_32x32x16_bf16 v[32:47], v[92:95], v[172:175], v[32:47]
    ds_read_b64_tr_b16 v[80:81], v2 offset:7168
    ds_read_b64_tr_b16 v[82:83], v2 offset:8192
    ds_read_b64_tr_b16 v[84:85], v3 offset:7168
    ds_read_b64_tr_b16 v[86:87], v3 offset:8192
    s_waitcnt vmcnt(13) lgkmcnt(8)
    v_mfma_f32_32x32x16_bf16 v[16:31], v[96:99], v[176:179], v[16:31]
    v_mfma_f32_32x32x16_bf16 v[32:47], v[100:103], v[176:179], v[32:47]
    ds_read_b64_tr_b16 v[88:89], v2 offset:9216
    ds_read_b64_tr_b16 v[90:91], v2 offset:10240
    ds_read_b64_tr_b16 v[92:93], v3 offset:9216
    ds_read_b64_tr_b16 v[94:95], v3 offset:10240
    s_waitcnt vmcnt(12) lgkmcnt(8)
    v_mfma_f32_32x32x16_bf16 v[16:31], v[104:107], v[180:183], v[16:31]
    v_mfma_f32_32x32x16_bf16 v[32:47], v[108:111], v[180:183], v[32:47]
    ds_read_b64_tr_b16 v[96:97], v2 offset:10752
    ds_read_b64_tr_b16 v[98:99], v2 offset:11776
    ds_read_b64_tr_b16 v[100:101], v3 offset:10752
    ds_read_b64_tr_b16 v[102:103], v3 offset:11776
    s_waitcnt vmcnt(11) lgkmcnt(8)
    v_mfma_f32_32x32x16_bf16 v[16:31], v[80:83], v[184:187], v[16:31]
    v_mfma_f32_32x32x16_bf16 v[32:47], v[84:87], v[184:187], v[32:47]
    ds_read_b64_tr_b16 v[104:105], v2 offset:12800
    ds_read_b64_tr_b16 v[106:107], v2 offset:13824
    ds_read_b64_tr_b16 v[108:109], v3 offset:12800
    ds_read_b64_tr_b16 v[110:111], v3 offset:13824
    s_waitcnt vmcnt(10) lgkmcnt(8)
    v_mfma_f32_32x32x16_bf16 v[16:31], v[88:91], v[188:191], v[16:31]
    v_mfma_f32_32x32x16_bf16 v[32:47], v[92:95], v[188:191], v[32:47]
    ds_read_b64_tr_b16 v[80:81], v2 offset:15360
    ds_read_b64_tr_b16 v[82:83], v2 offset:16384
    ds_read_b64_tr_b16 v[84:85], v3 offset:15360
    ds_read_b64_tr_b16 v[86:87], v3 offset:16384
    s_waitcnt vmcnt(9) lgkmcnt(8)
    v_mfma_f32_32x32x16_bf16 v[16:31], v[96:99], v[192:195], v[16:31]
    v_mfma_f32_32x32x16_bf16 v[32:47], v[100:103], v[192:195], v[32:47]
    ds_read_b64_tr_b16 v[88:89], v2 offset:17408
    ds_read_b64_tr_b16 v[90:91], v2 offset:18432
    ds_read_b64_tr_b16 v[92:93], v3 offset:17408
    ds_read_b64_tr_b16 v[94:95], v3 offset:18432
    s_waitcnt vmcnt(8) lgkmcnt(8)
    v_mfma_f32_32x32x16_bf16 v[16:31], v[104:107], v[196:199], v[16:31]
    v_mfma_f32_32x32x16_bf16 v[32:47], v[108:111], v[196:199], v[32:47]
    ds_read_b64_tr_b16 v[96:97], v2 offset:18944
    ds_read_b64_tr_b16 v[98:99], v2 offset:19968
    ds_read_b64_tr_b16 v[100:101], v3 offset:18944
    ds_read_b64_tr_b16 v[102:103], v3 offset:19968
    s_waitcnt vmcnt(7) lgkmcnt(8)
    v_mfma_f32_32x32x16_bf16 v[16:31], v[80:83], v[200:203], v[16:31]
    v_mfma_f32_32x32x16_bf16 v[32:47], v[84:87], v[200:203], v[32:47]
    ds_read_b64_tr_b16 v[104:105], v2 offset:20992
    ds_read_b64_tr_b16 v[106:107], v2 offset:22016
    ds_read_b64_tr_b16 v[108:109], v3 offset:20992
    ds_read_b64_tr_b16 v[110:111], v3 offset:22016
    s_waitcnt vmcnt(6) lgkmcnt(8)
    v_mfma_f32_32x32x16_bf16 v[16:31], v[88:91], v[204:207], v[16:31]
    v_mfma_f32_32x32x16_bf16 v[32:47], v[92:95], v[204:207], v[32:47]
    ds_read_b64_tr_b16 v[80:81], v2 offset:22528
    ds_read_b64_tr_b16 v[82:83], v2 offset:23552
    ds_read_b64_tr_b16 v[84:85], v3 offset:22528
    ds_read_b64_tr_b16 v[86:87], v3 offset:23552
    s_waitcnt vmcnt(5) lgkmcnt(8)
    v_mfma_f32_32x32x16_bf16 v[16:31], v[96:99], v[208:211], v[16:31]
    v_mfma_f32_32x32x16_bf16 v[32:47], v[100:103], v[208:211], v[32:47]
    ds_read_b64_tr_b16 v[88:89], v2 offset:24576
    ds_read_b64_tr_b16 v[90:91], v2 offset:25600
    ds_read_b64_tr_b16 v[92:93], v3 offset:24576
    ds_read_b64_tr_b16 v[94:95], v3 offset:25600
    s_waitcnt vmcnt(4) lgkmcnt(8)
    v_mfma_f32_32x32x16_bf16 v[16:31], v[104:107], v[212:215], v[16:31]
    v_mfma_f32_32x32x16_bf16 v[32:47], v[108:111], v[212:215], v[32:47]
    ds_read_b64_tr_b16 v[96:97], v2 offset:26112
    ds_read_b64_tr_b16 v[98:99], v2 offset:27136
    ds_read_b64_tr_b16 v[100:101], v3 offset:26112
    ds_read_b64_tr_b16 v[102:103], v3 offset:27136
    buffer_load_dword v15, v14, s[36:39], 0 offen sc1
    s_waitcnt vmcnt(4) lgkmcnt(8)
    v_mfma_f32_32x32x16_bf16 v[16:31], v[80:83], v[216:219], v[16:31]
    v_mfma_f32_32x32x16_bf16 v[32:47], v[84:87], v[216:219], v[32:47]
    ds_read_b64_tr_b16 v[104:105], v2 offset:28160
    ds_read_b64_tr_b16 v[106:107], v2 offset:29184
    ds_read_b64_tr_b16 v[108:109], v3 offset:28160
    ds_read_b64_tr_b16 v[110:111], v3 offset:29184
    s_waitcnt vmcnt(3) lgkmcnt(8)
    v_mfma_f32_32x32x16_bf16 v[16:31], v[88:91], v[220:223], v[16:31]
    v_mfma_f32_32x32x16_bf16 v[32:47], v[92:95], v[220:223], v[32:47]
    s_waitcnt vmcnt(2) lgkmcnt(4)
    v_mfma_f32_32x32x16_bf16 v[16:31], v[96:99], v[240:243], v[16:31]
    v_mfma_f32_32x32x16_bf16 v[32:47], v[100:103], v[240:243], v[32:47]
    s_waitcnt vmcnt(1) lgkmcnt(0)
    v_mfma_f32_32x32x16_bf16 v[16:31], v[104:107], v[244:247], v[16:31]
    v_mfma_f32_32x32x16_bf16 v[32:47], v[108:111], v[244:247], v[32:47]
    s_nop 11
    ds_write_b128 v10, v[32:35] offset:0
    ds_write_b128 v10, v[36:39] offset:1024
    ds_write_b128 v10, v[40:43] offset:2048
    ds_write_b128 v10, v[44:47] offset:3072
    s_waitcnt lgkmcnt(0)
    s_mov_b64 exec, 1
    v_mov_b32 v8, 159744
    v_mov_b32 v9, 1
    ds_add_u32 v8, v9
    s_mov_b64 exec, -1
    v_add_f32 v16, v16, v224
    v_add_f32 v17, v17, v225
    v_add_f32 v18, v18, v226
    v_add_f32 v19, v19, v227
    v_add_f32 v20, v20, v228
    v_add_f32 v21, v21, v229
    v_add_f32 v22, v22, v230
    v_add_f32 v23, v23, v231
    v_add_f32 v24, v24, v232
    v_add_f32 v25, v25, v233
    v_add_f32 v26, v26, v234
    v_add_f32 v27, v27, v235
    v_add_f32 v28, v28, v236
    v_add_f32 v29, v29, v237
    v_add_f32 v30, v30, v238
    v_add_f32 v31, v31, v239
    s_mov_b32 s58, 524288
    v_mov_b32 v8, 159744
GL_47:
    ds_read_b32 v9, v8
    s_sub_u32 s58, s58, 1
    s_cbranch_scc1 GD_48
    s_waitcnt lgkmcnt(0)
    v_readfirstlane_b32 s3, v9
    s_nop 1
    s_cmp_lt_u32 s3, 36
    s_cbranch_scc1 GL_47
GD_48:
    s_waitcnt lgkmcnt(0)
    ds_read_b128 v[32:35], v11 offset:0
    ds_read_b128 v[36:39], v11 offset:1024
    ds_read_b128 v[40:43], v11 offset:2048
    ds_read_b128 v[44:47], v11 offset:3072
    s_waitcnt vmcnt(0)
    v_cmp_eq_u32 vcc, 0, v15
    s_nop 1
    s_cbranch_vccz B_pready
    s_mov_b32 s58, 65536
    s_mov_b64 exec, 1
PL_49:
    buffer_load_dword v9, v14, s[36:39], 0 offen sc1
    s_waitcnt vmcnt(0)
    v_cmp_eq_u32 vcc, 0, v9
    s_nop 1
    s_cbranch_vccz PD_50
    s_sleep 1
    s_sub_u32 s58, s58, 1
    s_cmp_lg_u32 s58, 0
    s_cbranch_scc1 PL_49
PD_50:
    s_mov_b64 exec, -1
B_pready:
    buffer_load_dwordx4 v[128:131], v0, s[36:39], s50 offen offset:0 sc1
    buffer_load_dwordx4 v[132:135], v0, s[36:39], s50 offen offset:1024 sc1
    s_waitcnt lgkmcnt(3)
    v_add_f32 v16, v16, v32
    v_add_f32 v17, v17, v33
    v_add_f32 v18, v18, v34
    v_add_f32 v19, v19, v35
    s_waitcnt lgkmcnt(2)
    v_add_f32 v20, v20, v36
    v_add_f32 v21, v21, v37
    v_add_f32 v22, v22, v38
    v_add_f32 v23, v23, v39
    s_waitcnt lgkmcnt(1)
    v_add_f32 v24, v24, v40
    v_add_f32 v25, v25, v41
    v_add_f32 v26, v26, v42
    v_add_f32 v27, v27, v43
    s_waitcnt lgkmcnt(0)
    v_add_f32 v28, v28, v44
    v_add_f32 v29, v29, v45
    v_add_f32 v30, v30, v46
    v_add_f32 v31, v31, v47
    s_waitcnt vmcnt(0)
    v_lshlrev_b32 v112, 16, v128
    v_and_b32 v113, 0xffff0000, v128
    v_lshlrev_b32 v114, 16, v129
    v_and_b32 v115, 0xffff0000, v129
    v_lshlrev_b32 v116, 16, v130
    v_and_b32 v117, 0xffff0000, v130
    v_lshlrev_b32 v118, 16, v131
    v_and_b32 v119, 0xffff0000, v131
    v_lshlrev_b32 v120, 16, v132
    v_and_b32 v121, 0xffff0000, v132
    v_lshlrev_b32 v122, 16, v133
    v_and_b32 v123, 0xffff0000, v133
    v_lshlrev_b32 v124, 16, v134
    v_and_b32 v125, 0xffff0000, v134
    v_lshlrev_b32 v126, 16, v135
    v_and_b32 v127, 0xffff0000, v135
    v_add_f32 v16, v16, v112
    v_add_f32 v17, v17, v113
    v_add_f32 v18, v18, v114
    v_add_f32 v19, v19, v115
    v_add_f32 v20, v20, v116
    v_add_f32 v21, v21, v117
    v_add_f32 v22, v22, v118
    v_add_f32 v23, v23, v119
    v_add_f32 v24, v24, v120
    v_add_f32 v25, v25, v121
    v_add_f32 v26, v26, v122
    v_add_f32 v27, v27, v123
    v_add_f32 v28, v28, v124
    v_add_f32 v29, v29, v125
    v_add_f32 v30, v30, v126
    v_add_f32 v31, v31, v127
    v_cvt_pk_bf16_f32 v128, v16, v17
    v_cvt_pk_bf16_f32 v129, v18, v19
    v_cvt_pk_bf16_f32 v130, v20, v21
    v_cvt_pk_bf16_f32 v131, v22, v23
    v_cvt_pk_bf16_f32 v132, v24, v25
    v_cvt_pk_bf16_f32 v133, v26, v27
    v_cvt_pk_bf16_f32 v134, v28, v29
    v_cvt_pk_bf16_f32 v135, v30, v31
    ds_write_b64 v4, v[128:129] offset:0
    ds_write_b64 v4, v[130:131] offset:16
    ds_write_b64 v4, v[132:133] offset:32
    ds_write_b64 v4, v[134:135] offset:48
    s_waitcnt lgkmcnt(0)
    s_mov_b64 exec, 1
    v_mov_b32 v8, 159744
    v_mov_b32 v9, 1
    ds_add_u32 v8, v9
    s_mov_b64 exec, -1
    s_mov_b32 s58, 524288
    v_mov_b32 v8, 159744
GL_51:
    ds_read_b32 v9, v8
    s_sub_u32 s58, s58, 1
    s_cbranch_scc1 GD_52
    s_waitcnt lgkmcnt(0)
    v_readfirstlane_b32 s3, v9
    s_nop 1
    s_cmp_lt_u32 s3, 40
    s_cbranch_scc1 GL_51
GD_52:
    s_waitcnt lgkmcnt(0)
    ds_read_b128 v[128:131], v5
    ds_read_b128 v[132:135], v5 offset:1152
    s_waitcnt lgkmcnt(1)
    buffer_store_dwordx4 v[128:131], v6, s[28:31], s27 offen nt
    s_waitcnt lgkmcnt(0)
    buffer_store_dwordx4 v[132:135], v6, s[28:31], s62 offen nt
    s_endpgm
K_end:
    s_endpgm
K_last:
.section .rodata,"a"
.p2align 6
.amdhsa_kernel parallel_sum__mha_block__mixer_s_mlp__prompt_kernel
  .amdhsa_next_free_vgpr 256
  .amdhsa_next_free_sgpr 102
  .amdhsa_accum_offset 256
  .amdhsa_group_segment_fixed_size 0
  .amdhsa_kernarg_size 88
  .amdhsa_user_sgpr_count 2
  .amdhsa_user_sgpr_kernarg_segment_ptr 1
  .amdhsa_system_sgpr_workgroup_id_x 1
.end_amdhsa_kernel
```
